```python
import torch

def _softmax(x, axis=-1):
    return torch.softmax(x, dim=axis)
def _gelu(x):
    return torch.nn.functional.gelu(x, approximate="tanh")
def _silu(x):
    return torch.nn.functional.silu(x)
def _sigmoid(x):
    return torch.sigmoid(x)
def _layernorm(x, axis=-1, eps=1e-5):
    m = x.mean(dim=axis, keepdim=True)
    v = x.var(dim=axis, keepdim=True, unbiased=False)
    return (x - m) / torch.sqrt(v + eps)
def _scatter_add(tgt, idx, src, axis=0):
    return tgt.clone().index_add_(axis, idx, src)
def _segment_sum(src, seg, n):
    out = torch.zeros((n,) + src.shape[1:], dtype=src.dtype)
    return out.index_add_(0, seg, src)
def _pad(x, pw):
    flat = tuple(v for pair in reversed(pw) for v in pair)
    return torch.nn.functional.pad(x, flat)

kernel_name = 'standalone__weight_only_int_quip_2__prompt'

def setup_inputs():

    _w = (lambda a: (lambda t: t.to(torch.bfloat16) if t.is_floating_point() else t)(torch.as_tensor(a)))
    B, S, D, F = 1, 2048, 576, 4608
    nbits = max(2, min(4, int(3)))
    G = 32 if 32 > 0 else D
    D = (D // G) * G
    ng = D // G
    qmax = 1 << nbits
    qw = torch.randint(0, qmax, (D, F)).to(torch.int32)
    zp = torch.randint(0, qmax, (ng, F)).to(float)
    sc = torch.abs((lambda *s: torch.randn(*s, dtype=torch.bfloat16) * 0.05)(ng, F)).to(float) * 0.1 + 0.02
    return {
        "x": _w((lambda *s: torch.randn(*s, dtype=torch.bfloat16) * 0.05)(B, S, D)),
        "qw": _w(qw),
        "scales": _w(sc),
        "zeros": _w(zp),
    }

def reference(x, qw, scales, zeros):
    B, S, D = x.shape
    ng, F = scales.shape
    G = D // ng
    s = (lambda x, n, axis: torch.repeat_interleave(x, n, dim=axis))(scales, G, axis=0)
    z = (lambda x, n, axis: torch.repeat_interleave(x, n, dim=axis))(zeros, G, axis=0)
    w = ((lambda x, dt: x.to(dt))(qw, x.dtype) - z) * s
    return torch.einsum("bsd,df->bsf", x, w)
```

```asm
; @launch grid=(256,1,1) block=(512,1,1) lds=156160
.amdgcn_target "amdgcn-amd-amdhsa--gfx950"
.text
.globl standalone__weight_only_int_quip_2__prompt_kernel
.p2align 8
.type standalone__weight_only_int_quip_2__prompt_kernel,@function
standalone__weight_only_int_quip_2__prompt_kernel:
s_cmp_ge_u32 s2, 256
s_cbranch_scc1 L_end
s_load_dwordx8 s[4:11], s[0:1], 0
s_cmp_ge_u32 s2, 32
s_cbranch_scc1 L_noicpf
s_getpc_b64 s[56:57]
L_pc:
s_sub_u32 s56, s56, L_pc - standalone__weight_only_int_quip_2__prompt_kernel
s_subb_u32 s57, s57, 0
v_lshlrev_b32 v17, 7, v0
v_cmp_gt_u32 vcc, L_end - standalone__weight_only_int_quip_2__prompt_kernel, v17
s_and_saveexec_b64 s[58:59], vcc
s_cbranch_execz L_icpf2
global_load_dword v18, v17, s[56:57]
L_icpf2:
s_mov_b64 exec, s[58:59]
L_noicpf:
s_load_dwordx2 s[12:13], s[0:1], 32
v_readfirstlane_b32 s38, v0
v_and_b32 v19, 63, v0
s_lshr_b32 s36, s2, 3
s_and_b32 s36, s36, 7
s_and_b32 s37, s2, 7
s_mul_i32 s37, s37, 576
s_lshr_b32 s51, s2, 6
s_mul_i32 s3, s51, 1
s_add_u32 s3, s3, s36
s_mul_i32 s52, s3, 32768
s_lshr_b32 s52, s52, 16
s_mul_i32 s52, s52, 2
s_sub_u32 s3, s3, s52
s_mul_i32 s3, s3, 4
s_lshl_b32 s55, s51, 7
s_add_u32 s55, s55, s37
s_lshl_b32 s54, s51, 4
s_add_u32 s54, s54, s37
s_add_u32 s54, s54, 512
s_lshr_b32 s38, s38, 6
s_and_b32 s39, s38, 3
s_mov_b32 s37, s3
s_cmp_ge_u32 s38, 4
s_cbranch_scc1 L_producer
v_lshl_add_u32 v122, s39, 6, v19
v_mul_u32_u24 v120, 3641, v122
v_lshrrev_b32 v120, 16, v120
v_mul_u32_u24 v121, 18, v120
v_sub_u32 v121, v122, v121
s_sub_u32 s51, s54, 128
v_mov_b32 v122, s51
v_mov_b32 v123, s55
v_cmp_gt_u32 vcc, 16, v121
s_nop 1
v_cndmask_b32 v122, v122, v123, vcc
v_lshl_add_u32 v122, v121, 3, v122
v_mul_u32_u24 v123, 4608, v120
v_add_lshl_u32 v122, v122, v123, 1
v_lshl_add_u32 v126, s39, 6, v19
v_add_u32 v126, 256, v126
v_mul_u32_u24 v124, 3641, v126
v_lshrrev_b32 v124, 16, v124
v_mul_u32_u24 v125, 18, v124
v_sub_u32 v125, v126, v125
s_sub_u32 s51, s54, 128
v_mov_b32 v126, s51
v_mov_b32 v127, s55
v_cmp_gt_u32 vcc, 16, v125
s_nop 1
v_cndmask_b32 v126, v126, v127, vcc
v_lshl_add_u32 v126, v125, 3, v126
v_mul_u32_u24 v127, 4608, v124
v_add_lshl_u32 v126, v126, v127, 1
s_mov_b32 s26, 165888
s_mov_b32 s27, 0x20000
s_mov_b32 s30, 165888
s_mov_b32 s31, 0x20000
s_mul_i32 s50, s36, 294912
s_waitcnt lgkmcnt(0)
s_mov_b32 s24, s8
s_mov_b32 s25, s9
s_mov_b32 s28, s10
s_mov_b32 s29, s11
buffer_load_dwordx4 v[128:131], v122, s[24:27], 0 offen
buffer_load_dwordx4 v[132:135], v122, s[28:31], 0 offen
buffer_load_dwordx4 v[136:139], v126, s[24:27], 0 offen
buffer_load_dwordx4 v[140:143], v126, s[28:31], 0 offen
s_add_u32 s4, s4, s50
s_addc_u32 s5, s5, 0
s_mov_b32 s18, 293888
s_mov_b32 s19, 0x20000
s_lshl_b32 s51, s37, 7
s_add_u32 s16, s4, s51
s_addc_u32 s17, s5, 0
s_mul_i32 s51, s36, 2359296
s_add_u32 s32, s12, s51
s_addc_u32 s33, s13, 0
s_mov_b32 s34, 2359296
s_mov_b32 s35, 0x20000
s_mul_i32 s53, s39, 24576
s_mov_b32 s41, 8192
s_mov_b32 s42, 16384
s_mov_b32 s43, 24576
s_mov_b32 s44, 36864
s_mov_b32 s45, 45056
s_mov_b32 s46, 53248
s_mov_b32 s47, 61440
s_setprio 1
v_lshrrev_b32 v112, 3, v19
s_lshl_b32 s52, s39, 6
v_add_u32 v112, s52, v112
v_mul_u32_u24 v112, 1152, v112
v_lshrrev_b32 v113, 4, v19
v_and_b32 v8, 7, v19
v_xor_b32 v8, v113, v8
v_lshl_add_u32 v8, v8, 4, v112
v_xor_b32 v9, 64, v8
v_and_b32 v112, 31, v19
v_lshrrev_b32 v113, 5, v19
v_bfe_u32 v114, v112, 1, 3
v_xor_b32 v114, v113, v114
v_lshlrev_b32 v114, 4, v114
v_lshl_add_u32 v114, v112, 7, v114
v_add_u32 v0, s53, v114
v_xor_b32 v1, 32, v0
v_xor_b32 v2, 64, v0
v_xor_b32 v3, 96, v0
v_and_b32 v112, 15, v19
v_lshrrev_b32 v113, 4, v19
v_lshrrev_b32 v114, 1, v112
v_xor_b32 v114, v113, v114
v_lshlrev_b32 v114, 4, v114
v_lshl_add_u32 v114, v112, 7, v114
v_add_u32 v4, s53, v114
v_xor_b32 v5, 64, v4
v_lshl_add_u32 v114, v113, 2, s52
v_mul_u32_u24 v114, 9216, v114
v_lshl_add_u32 v114, v112, 4, v114
s_lshl_b32 s51, s55, 1
v_add_u32 v10, s51, v114
v_lshlrev_b32 v6, 4, v19
v_add_u32 v6, 98304, v6
v_add_u32 v114, s52, v112
v_mul_u32_u24 v114, 9216, v114
v_lshl_add_u32 v114, v113, 3, v114
s_lshl_b32 s51, s54, 1
v_add_u32 v11, s51, v114
v_lshrrev_b32 v114, 1, v113
v_and_b32 v115, 1, v113
v_lshlrev_b32 v7, 9, v114
v_lshl_add_u32 v7, v115, 7, v7
v_lshl_add_u32 v7, v112, 3, v7
v_add_u32 v7, 114816, v7
s_lshl_b32 s51, s3, 1
v_subrev_u32 v122, s51, v120
v_add_u32 v123, 18, v122
v_min_u32 v122, v122, v123
v_mul_u32_u24 v122, 576, v122
v_lshl_add_u32 v122, v121, 5, v122
v_add_u32 v122, 135424, v122
s_lshl_b32 s51, s3, 1
v_subrev_u32 v126, s51, v124
v_add_u32 v127, 18, v126
v_min_u32 v126, v126, v127
v_mul_u32_u24 v126, 576, v126
v_lshl_add_u32 v126, v125, 5, v126
v_add_u32 v126, 135424, v126
s_waitcnt vmcnt(0)
v_lshlrev_b32 v144, 16, v128
v_and_b32 v145, 0xffff0000, v128
v_lshlrev_b32 v152, 16, v132
v_and_b32 v153, 0xffff0000, v132
v_lshlrev_b32 v146, 16, v129
v_and_b32 v147, 0xffff0000, v129
v_lshlrev_b32 v154, 16, v133
v_and_b32 v155, 0xffff0000, v133
v_lshlrev_b32 v148, 16, v130
v_and_b32 v149, 0xffff0000, v130
v_lshlrev_b32 v156, 16, v134
v_and_b32 v157, 0xffff0000, v134
v_lshlrev_b32 v150, 16, v131
v_and_b32 v151, 0xffff0000, v131
v_lshlrev_b32 v158, 16, v135
v_and_b32 v159, 0xffff0000, v135
v_mul_f32 v152, v152, v144
v_mul_f32 v153, v153, v145
v_mul_f32 v154, v154, v146
v_mul_f32 v155, v155, v147
v_mul_f32 v156, v156, v148
v_mul_f32 v157, v157, v149
v_mul_f32 v158, v158, v150
v_mul_f32 v159, v159, v151
ds_write_b128 v122, v[144:147]
ds_write_b128 v122, v[148:151] offset:16
ds_write_b128 v122, v[152:155] offset:10368
ds_write_b128 v122, v[156:159] offset:10384
v_cmp_gt_u32 vcc, 18, v124
s_and_saveexec_b64 s[56:57], vcc
s_cbranch_execz L_tskip
v_lshlrev_b32 v160, 16, v136
v_and_b32 v161, 0xffff0000, v136
v_lshlrev_b32 v168, 16, v140
v_and_b32 v169, 0xffff0000, v140
v_lshlrev_b32 v162, 16, v137
v_and_b32 v163, 0xffff0000, v137
v_lshlrev_b32 v170, 16, v141
v_and_b32 v171, 0xffff0000, v141
v_lshlrev_b32 v164, 16, v138
v_and_b32 v165, 0xffff0000, v138
v_lshlrev_b32 v172, 16, v142
v_and_b32 v173, 0xffff0000, v142
v_lshlrev_b32 v166, 16, v139
v_and_b32 v167, 0xffff0000, v139
v_lshlrev_b32 v174, 16, v143
v_and_b32 v175, 0xffff0000, v143
v_mul_f32 v168, v168, v160
v_mul_f32 v169, v169, v161
v_mul_f32 v170, v170, v162
v_mul_f32 v171, v171, v163
v_mul_f32 v172, v172, v164
v_mul_f32 v173, v173, v165
v_mul_f32 v174, v174, v166
v_mul_f32 v175, v175, v167
ds_write_b128 v126, v[160:163]
ds_write_b128 v126, v[164:167] offset:16
ds_write_b128 v126, v[168:171] offset:10368
ds_write_b128 v126, v[172:175] offset:10384
L_tskip:
s_mov_b64 exec, s[56:57]
s_waitcnt lgkmcnt(0)
s_barrier
s_add_u32 m0, s53, 0
s_nop 0
buffer_load_dwordx4 v8, s[16:19], 0 offen offset:0  lds
buffer_load_dwordx4 v9, s[16:19], s41 offen offset:1024  lds
buffer_load_dwordx4 v8, s[16:19], s42 offen offset:2048  lds
buffer_load_dwordx4 v9, s[16:19], s43 offen offset:3072  lds
s_add_u32 m0, s53, 4096
s_nop 0
buffer_load_dwordx4 v8, s[16:19], s44 offen offset:0  lds
buffer_load_dwordx4 v9, s[16:19], s45 offen offset:1024  lds
buffer_load_dwordx4 v8, s[16:19], s46 offen offset:2048  lds
buffer_load_dwordx4 v9, s[16:19], s47 offen offset:3072  lds
s_add_u32 s37, s37, 1
s_cmp_eq_u32 s37, 9
s_cselect_b32 s37, 0, s37
s_lshl_b32 s51, s37, 7
s_add_u32 s16, s4, s51
s_addc_u32 s17, s5, 0
s_add_u32 m0, s53, 8192
s_nop 0
buffer_load_dwordx4 v8, s[16:19], 0 offen offset:0  lds
buffer_load_dwordx4 v9, s[16:19], s41 offen offset:1024  lds
buffer_load_dwordx4 v8, s[16:19], s42 offen offset:2048  lds
buffer_load_dwordx4 v9, s[16:19], s43 offen offset:3072  lds
s_add_u32 m0, s53, 12288
s_nop 0
buffer_load_dwordx4 v8, s[16:19], s44 offen offset:0  lds
buffer_load_dwordx4 v9, s[16:19], s45 offen offset:1024  lds
buffer_load_dwordx4 v8, s[16:19], s46 offen offset:2048  lds
buffer_load_dwordx4 v9, s[16:19], s47 offen offset:3072  lds
s_add_u32 s37, s37, 1
s_cmp_eq_u32 s37, 9
s_cselect_b32 s37, 0, s37
s_lshl_b32 s51, s37, 7
s_add_u32 s16, s4, s51
s_addc_u32 s17, s5, 0
s_add_u32 m0, s53, 16384
s_nop 0
buffer_load_dwordx4 v8, s[16:19], 0 offen offset:0  lds
buffer_load_dwordx4 v9, s[16:19], s41 offen offset:1024  lds
buffer_load_dwordx4 v8, s[16:19], s42 offen offset:2048  lds
buffer_load_dwordx4 v9, s[16:19], s43 offen offset:3072  lds
s_add_u32 m0, s53, 20480
s_nop 0
buffer_load_dwordx4 v8, s[16:19], s44 offen offset:0  lds
buffer_load_dwordx4 v9, s[16:19], s45 offen offset:1024  lds
buffer_load_dwordx4 v8, s[16:19], s46 offen offset:2048  lds
buffer_load_dwordx4 v9, s[16:19], s47 offen offset:3072  lds
s_add_u32 s37, s37, 1
s_cmp_eq_u32 s37, 9
s_cselect_b32 s37, 0, s37
s_lshl_b32 s51, s37, 7
s_add_u32 s16, s4, s51
s_addc_u32 s17, s5, 0
s_barrier
s_waitcnt vmcnt(20)
ds_read_b128 v[12:15], v4 offset:0
ds_read_b128 v[16:19], v6 offset:0
ds_read_b128 v[20:23], v4 offset:2048
ds_read_b128 v[24:27], v6 offset:1024
ds_read_b128 v[28:31], v6 offset:2048
s_waitcnt vmcnt(16)
ds_read_b128 v[32:35], v4 offset:4096
ds_read_b128 v[36:39], v6 offset:3072
ds_read_b128 v[40:43], v6 offset:4160
s_waitcnt lgkmcnt(6)
v_mfma_f32_16x16x32_bf16 v[112:115], v[12:15], v[16:19], 0
ds_read_b128 v[44:47], v4 offset:6144
s_waitcnt lgkmcnt(6)
v_mfma_f32_16x16x32_bf16 v[144:147], v[20:23], v[16:19], 0
ds_read_b128 v[48:51], v6 offset:5184
s_waitcnt lgkmcnt(4)
v_mfma_f32_16x16x32_bf16 v[176:179], v[32:35], v[16:19], 0
ds_read_b128 v[52:55], v6 offset:6208
s_waitcnt lgkmcnt(2)
v_mfma_f32_16x16x32_bf16 v[208:211], v[44:47], v[16:19], 0
v_mfma_f32_16x16x32_bf16 v[116:119], v[12:15], v[24:27], 0
ds_read_b128 v[56:59], v6 offset:7232
v_mfma_f32_16x16x32_bf16 v[148:151], v[20:23], v[24:27], 0
v_mfma_f32_16x16x32_bf16 v[180:183], v[32:35], v[24:27], 0
v_mfma_f32_16x16x32_bf16 v[212:215], v[44:47], v[24:27], 0
v_mfma_f32_16x16x32_bf16 v[120:123], v[12:15], v[28:31], 0
ds_read_b64_tr_b16 v[60:61], v7 offset:0
ds_read_b64_tr_b16 v[62:63], v7 offset:256
v_mfma_f32_16x16x32_bf16 v[152:155], v[20:23], v[28:31], 0
v_mfma_f32_16x16x32_bf16 v[184:187], v[32:35], v[28:31], 0
v_mfma_f32_16x16x32_bf16 v[216:219], v[44:47], v[28:31], 0
v_mfma_f32_16x16x32_bf16 v[124:127], v[12:15], v[36:39], 0
ds_read_b128 v[64:67], v6 offset:8256
v_mfma_f32_16x16x32_bf16 v[156:159], v[20:23], v[36:39], 0
ds_read_b128 v[68:71], v5 offset:0
v_mfma_f32_16x16x32_bf16 v[188:191], v[32:35], v[36:39], 0
ds_read_b128 v[72:75], v5 offset:2048
v_mfma_f32_16x16x32_bf16 v[220:223], v[44:47], v[36:39], 0
ds_read_b128 v[76:79], v5 offset:4096
v_mfma_f32_16x16x32_bf16 v[128:131], v[12:15], v[40:43], 0
ds_read_b128 v[80:83], v5 offset:6144
v_mfma_f32_16x16x32_bf16 v[160:163], v[20:23], v[40:43], 0
ds_read_b128 v[84:87], v6 offset:9280
v_mfma_f32_16x16x32_bf16 v[192:195], v[32:35], v[40:43], 0
v_mfma_f32_16x16x32_bf16 v[224:227], v[44:47], v[40:43], 0
s_waitcnt lgkmcnt(1)
v_mfma_f32_16x16x32_bf16 v[132:135], v[12:15], v[48:51], 0
s_add_u32 m0, s53, 0
s_nop 0
v_mfma_f32_16x16x32_bf16 v[164:167], v[20:23], v[48:51], 0
ds_read_b128 v[88:91], v6 offset:10304
v_mfma_f32_16x16x32_bf16 v[196:199], v[32:35], v[48:51], 0
v_mfma_f32_16x16x32_bf16 v[228:231], v[44:47], v[48:51], 0
v_mfma_f32_16x16x32_bf16 v[136:139], v[12:15], v[52:55], 0
ds_read_b128 v[92:95], v6 offset:11328
v_mfma_f32_16x16x32_bf16 v[168:171], v[20:23], v[52:55], 0
v_mfma_f32_16x16x32_bf16 v[200:203], v[32:35], v[52:55], 0
v_mfma_f32_16x16x32_bf16 v[232:235], v[44:47], v[52:55], 0
v_mfma_f32_16x16x32_bf16 v[140:143], v[12:15], v[56:59], 0
buffer_load_dwordx4 v8, s[16:19], 0 offen offset:0  lds
v_mfma_f32_16x16x32_bf16 v[172:175], v[20:23], v[56:59], 0
ds_read_b128 v[96:99], v6 offset:12416
v_mfma_f32_16x16x32_bf16 v[204:207], v[32:35], v[56:59], 0
v_mfma_f32_16x16x32_bf16 v[236:239], v[44:47], v[56:59], 0
v_mfma_f32_16x16x32_bf16 v[240:243], v[60:63], v[12:15], 0
ds_read_b128 v[16:19], v6 offset:13440
v_mfma_f32_16x16x32_bf16 v[244:247], v[60:63], v[20:23], 0
v_mfma_f32_16x16x32_bf16 v[248:251], v[60:63], v[32:35], 0
v_mfma_f32_16x16x32_bf16 v[252:255], v[60:63], v[44:47], 0
v_mfma_f32_16x16x32_bf16 v[112:115], v[68:71], v[64:67], v[112:115]
buffer_load_dwordx4 v9, s[16:19], s41 offen offset:1024  lds
v_mfma_f32_16x16x32_bf16 v[144:147], v[72:75], v[64:67], v[144:147]
ds_read_b128 v[24:27], v6 offset:14464
v_mfma_f32_16x16x32_bf16 v[176:179], v[76:79], v[64:67], v[176:179]
v_mfma_f32_16x16x32_bf16 v[208:211], v[80:83], v[64:67], v[208:211]
s_waitcnt lgkmcnt(2)
v_mfma_f32_16x16x32_bf16 v[116:119], v[68:71], v[84:87], v[116:119]
ds_read_b128 v[28:31], v6 offset:15488
v_mfma_f32_16x16x32_bf16 v[148:151], v[72:75], v[84:87], v[148:151]
v_mfma_f32_16x16x32_bf16 v[180:183], v[76:79], v[84:87], v[180:183]
v_mfma_f32_16x16x32_bf16 v[212:215], v[80:83], v[84:87], v[212:215]
v_mfma_f32_16x16x32_bf16 v[120:123], v[68:71], v[88:91], v[120:123]
buffer_load_dwordx4 v8, s[16:19], s42 offen offset:2048  lds
v_mfma_f32_16x16x32_bf16 v[152:155], v[72:75], v[88:91], v[152:155]
ds_read_b64_tr_b16 v[36:37], v7 offset:1024
ds_read_b64_tr_b16 v[38:39], v7 offset:1280
v_mfma_f32_16x16x32_bf16 v[184:187], v[76:79], v[88:91], v[184:187]
v_mfma_f32_16x16x32_bf16 v[216:219], v[80:83], v[88:91], v[216:219]
v_mfma_f32_16x16x32_bf16 v[124:127], v[68:71], v[92:95], v[124:127]
s_waitcnt vmcnt(15)
ds_read_b128 v[40:43], v4 offset:8192
v_mfma_f32_16x16x32_bf16 v[156:159], v[72:75], v[92:95], v[156:159]
ds_read_b128 v[48:51], v4 offset:10240
v_mfma_f32_16x16x32_bf16 v[188:191], v[76:79], v[92:95], v[188:191]
s_waitcnt vmcnt(11)
ds_read_b128 v[52:55], v4 offset:12288
v_mfma_f32_16x16x32_bf16 v[220:223], v[80:83], v[92:95], v[220:223]
ds_read_b128 v[56:59], v4 offset:14336
v_mfma_f32_16x16x32_bf16 v[128:131], v[68:71], v[96:99], v[128:131]
buffer_load_dwordx4 v9, s[16:19], s43 offen offset:3072  lds
v_mfma_f32_16x16x32_bf16 v[160:163], v[72:75], v[96:99], v[160:163]
s_waitcnt lgkmcnt(4)
s_barrier
ds_read_b128 v[12:15], v6 offset:18560
v_mfma_f32_16x16x32_bf16 v[192:195], v[76:79], v[96:99], v[192:195]
ds_read_b128 v[20:23], v6 offset:19584
v_mfma_f32_16x16x32_bf16 v[224:227], v[80:83], v[96:99], v[224:227]
v_mfma_f32_16x16x32_bf16 v[132:135], v[68:71], v[16:19], v[132:135]
ds_read_b128 v[32:35], v6 offset:20608
v_mfma_f32_16x16x32_bf16 v[164:167], v[72:75], v[16:19], v[164:167]
s_add_u32 m0, s53, 4096
s_nop 0
v_mfma_f32_16x16x32_bf16 v[196:199], v[76:79], v[16:19], v[196:199]
v_mfma_f32_16x16x32_bf16 v[228:231], v[80:83], v[16:19], v[228:231]
v_mfma_f32_16x16x32_bf16 v[136:139], v[68:71], v[24:27], v[136:139]
ds_read_b128 v[60:63], v6 offset:21632
v_mfma_f32_16x16x32_bf16 v[168:171], v[72:75], v[24:27], v[168:171]
v_mfma_f32_16x16x32_bf16 v[200:203], v[76:79], v[24:27], v[200:203]
v_mfma_f32_16x16x32_bf16 v[232:235], v[80:83], v[24:27], v[232:235]
v_mfma_f32_16x16x32_bf16 v[140:143], v[68:71], v[28:31], v[140:143]
ds_read_b128 v[44:47], v6 offset:22720
v_mfma_f32_16x16x32_bf16 v[172:175], v[72:75], v[28:31], v[172:175]
buffer_load_dwordx4 v8, s[16:19], s44 offen offset:0  lds
v_mfma_f32_16x16x32_bf16 v[204:207], v[76:79], v[28:31], v[204:207]
v_mfma_f32_16x16x32_bf16 v[236:239], v[80:83], v[28:31], v[236:239]
v_mfma_f32_16x16x32_bf16 v[240:243], v[36:39], v[68:71], v[240:243]
ds_read_b128 v[64:67], v6 offset:23744
v_mfma_f32_16x16x32_bf16 v[244:247], v[36:39], v[72:75], v[244:247]
v_mfma_f32_16x16x32_bf16 v[248:251], v[36:39], v[76:79], v[248:251]
v_mfma_f32_16x16x32_bf16 v[252:255], v[36:39], v[80:83], v[252:255]
s_waitcnt lgkmcnt(2)
v_mfma_f32_16x16x32_bf16 v[112:115], v[40:43], v[12:15], v[112:115]
ds_read_b128 v[84:87], v6 offset:24768
v_mfma_f32_16x16x32_bf16 v[144:147], v[48:51], v[12:15], v[144:147]
buffer_load_dwordx4 v9, s[16:19], s45 offen offset:1024  lds
v_mfma_f32_16x16x32_bf16 v[176:179], v[52:55], v[12:15], v[176:179]
v_mfma_f32_16x16x32_bf16 v[208:211], v[56:59], v[12:15], v[208:211]
v_mfma_f32_16x16x32_bf16 v[116:119], v[40:43], v[20:23], v[116:119]
ds_read_b128 v[88:91], v6 offset:25792
v_mfma_f32_16x16x32_bf16 v[148:151], v[48:51], v[20:23], v[148:151]
v_mfma_f32_16x16x32_bf16 v[180:183], v[52:55], v[20:23], v[180:183]
v_mfma_f32_16x16x32_bf16 v[212:215], v[56:59], v[20:23], v[212:215]
v_mfma_f32_16x16x32_bf16 v[120:123], v[40:43], v[32:35], v[120:123]
ds_read_b64_tr_b16 v[92:93], v7 offset:18560
ds_read_b64_tr_b16 v[94:95], v7 offset:18816
v_mfma_f32_16x16x32_bf16 v[152:155], v[48:51], v[32:35], v[152:155]
buffer_load_dwordx4 v8, s[16:19], s46 offen offset:2048  lds
v_mfma_f32_16x16x32_bf16 v[184:187], v[52:55], v[32:35], v[184:187]
v_mfma_f32_16x16x32_bf16 v[216:219], v[56:59], v[32:35], v[216:219]
v_mfma_f32_16x16x32_bf16 v[124:127], v[40:43], v[60:63], v[124:127]
ds_read_b128 v[96:99], v6 offset:26816
v_mfma_f32_16x16x32_bf16 v[156:159], v[48:51], v[60:63], v[156:159]
ds_read_b128 v[16:19], v5 offset:8192
v_mfma_f32_16x16x32_bf16 v[188:191], v[52:55], v[60:63], v[188:191]
ds_read_b128 v[24:27], v5 offset:10240
v_mfma_f32_16x16x32_bf16 v[220:223], v[56:59], v[60:63], v[220:223]
ds_read_b128 v[28:31], v5 offset:12288
s_waitcnt lgkmcnt(6)
v_mfma_f32_16x16x32_bf16 v[128:131], v[40:43], v[44:47], v[128:131]
ds_read_b128 v[68:71], v5 offset:14336
v_mfma_f32_16x16x32_bf16 v[160:163], v[48:51], v[44:47], v[160:163]
buffer_load_dwordx4 v9, s[16:19], s47 offen offset:3072  lds
v_mfma_f32_16x16x32_bf16 v[192:195], v[52:55], v[44:47], v[192:195]
ds_read_b128 v[72:75], v6 offset:27840
v_mfma_f32_16x16x32_bf16 v[224:227], v[56:59], v[44:47], v[224:227]
v_mfma_f32_16x16x32_bf16 v[132:135], v[40:43], v[64:67], v[132:135]
ds_read_b128 v[76:79], v6 offset:28864
v_mfma_f32_16x16x32_bf16 v[164:167], v[48:51], v[64:67], v[164:167]
v_mfma_f32_16x16x32_bf16 v[196:199], v[52:55], v[64:67], v[196:199]
v_mfma_f32_16x16x32_bf16 v[228:231], v[56:59], v[64:67], v[228:231]
v_mfma_f32_16x16x32_bf16 v[136:139], v[40:43], v[84:87], v[136:139]
ds_read_b128 v[36:39], v6 offset:29888
v_mfma_f32_16x16x32_bf16 v[168:171], v[48:51], v[84:87], v[168:171]
s_add_u32 s37, s37, 1
s_cmp_eq_u32 s37, 9
s_cselect_b32 s37, 0, s37
s_lshl_b32 s51, s37, 7
s_add_u32 s16, s4, s51
s_addc_u32 s17, s5, 0
v_mfma_f32_16x16x32_bf16 v[200:203], v[52:55], v[84:87], v[200:203]
v_mfma_f32_16x16x32_bf16 v[232:235], v[56:59], v[84:87], v[232:235]
v_mfma_f32_16x16x32_bf16 v[140:143], v[40:43], v[88:91], v[140:143]
ds_read_b128 v[80:83], v6 offset:30976
v_mfma_f32_16x16x32_bf16 v[172:175], v[48:51], v[88:91], v[172:175]
v_mfma_f32_16x16x32_bf16 v[204:207], v[52:55], v[88:91], v[204:207]
v_mfma_f32_16x16x32_bf16 v[236:239], v[56:59], v[88:91], v[236:239]
s_waitcnt lgkmcnt(2)
v_mfma_f32_16x16x32_bf16 v[240:243], v[92:95], v[40:43], v[240:243]
ds_read_b128 v[12:15], v6 offset:32000
v_mfma_f32_16x16x32_bf16 v[244:247], v[92:95], v[48:51], v[244:247]
s_add_u32 m0, s53, 8192
s_nop 0
v_mfma_f32_16x16x32_bf16 v[248:251], v[92:95], v[52:55], v[248:251]
v_mfma_f32_16x16x32_bf16 v[252:255], v[92:95], v[56:59], v[252:255]
v_mfma_f32_16x16x32_bf16 v[112:115], v[16:19], v[96:99], v[112:115]
ds_read_b128 v[20:23], v6 offset:33024
v_mfma_f32_16x16x32_bf16 v[144:147], v[24:27], v[96:99], v[144:147]
v_mfma_f32_16x16x32_bf16 v[176:179], v[28:31], v[96:99], v[176:179]
v_mfma_f32_16x16x32_bf16 v[208:211], v[68:71], v[96:99], v[208:211]
v_mfma_f32_16x16x32_bf16 v[116:119], v[16:19], v[72:75], v[116:119]
ds_read_b128 v[32:35], v6 offset:34048
v_mfma_f32_16x16x32_bf16 v[148:151], v[24:27], v[72:75], v[148:151]
buffer_load_dwordx4 v8, s[16:19], 0 offen offset:0  lds
v_mfma_f32_16x16x32_bf16 v[180:183], v[28:31], v[72:75], v[180:183]
v_mfma_f32_16x16x32_bf16 v[212:215], v[68:71], v[72:75], v[212:215]
v_mfma_f32_16x16x32_bf16 v[120:123], v[16:19], v[76:79], v[120:123]
ds_read_b64_tr_b16 v[60:61], v7 offset:19584
ds_read_b64_tr_b16 v[62:63], v7 offset:19840
v_mfma_f32_16x16x32_bf16 v[152:155], v[24:27], v[76:79], v[152:155]
v_mfma_f32_16x16x32_bf16 v[184:187], v[28:31], v[76:79], v[184:187]
v_mfma_f32_16x16x32_bf16 v[216:219], v[68:71], v[76:79], v[216:219]
s_waitcnt lgkmcnt(3)
v_mfma_f32_16x16x32_bf16 v[124:127], v[16:19], v[36:39], v[124:127]
s_waitcnt vmcnt(13)
ds_read_b128 v[44:47], v4 offset:16384
v_mfma_f32_16x16x32_bf16 v[156:159], v[24:27], v[36:39], v[156:159]
buffer_load_dwordx4 v9, s[16:19], s41 offen offset:1024  lds
v_mfma_f32_16x16x32_bf16 v[188:191], v[28:31], v[36:39], v[188:191]
ds_read_b128 v[64:67], v4 offset:18432
v_mfma_f32_16x16x32_bf16 v[220:223], v[68:71], v[36:39], v[220:223]
s_waitcnt vmcnt(10)
ds_read_b128 v[84:87], v4 offset:20480
v_mfma_f32_16x16x32_bf16 v[128:131], v[16:19], v[80:83], v[128:131]
s_waitcnt lgkmcnt(3)
s_barrier
ds_read_b128 v[88:91], v6 offset:0
v_mfma_f32_16x16x32_bf16 v[160:163], v[24:27], v[80:83], v[160:163]
ds_read_b128 v[40:43], v4 offset:22528
v_mfma_f32_16x16x32_bf16 v[192:195], v[28:31], v[80:83], v[192:195]
ds_read_b128 v[48:51], v6 offset:1024
v_mfma_f32_16x16x32_bf16 v[224:227], v[68:71], v[80:83], v[224:227]
v_mfma_f32_16x16x32_bf16 v[132:135], v[16:19], v[12:15], v[132:135]
ds_read_b128 v[52:55], v6 offset:2048
v_mfma_f32_16x16x32_bf16 v[164:167], v[24:27], v[12:15], v[164:167]
buffer_load_dwordx4 v8, s[16:19], s42 offen offset:2048  lds
v_mfma_f32_16x16x32_bf16 v[196:199], v[28:31], v[12:15], v[196:199]
v_mfma_f32_16x16x32_bf16 v[228:231], v[68:71], v[12:15], v[228:231]
v_mfma_f32_16x16x32_bf16 v[136:139], v[16:19], v[20:23], v[136:139]
ds_read_b128 v[92:95], v6 offset:3072
v_mfma_f32_16x16x32_bf16 v[168:171], v[24:27], v[20:23], v[168:171]
v_mfma_f32_16x16x32_bf16 v[200:203], v[28:31], v[20:23], v[200:203]
v_mfma_f32_16x16x32_bf16 v[232:235], v[68:71], v[20:23], v[232:235]
v_mfma_f32_16x16x32_bf16 v[140:143], v[16:19], v[32:35], v[140:143]
ds_read_b128 v[56:59], v6 offset:4160
v_mfma_f32_16x16x32_bf16 v[172:175], v[24:27], v[32:35], v[172:175]
buffer_load_dwordx4 v9, s[16:19], s43 offen offset:3072  lds
v_mfma_f32_16x16x32_bf16 v[204:207], v[28:31], v[32:35], v[204:207]
v_mfma_f32_16x16x32_bf16 v[236:239], v[68:71], v[32:35], v[236:239]
v_mfma_f32_16x16x32_bf16 v[240:243], v[60:63], v[16:19], v[240:243]
ds_read_b128 v[96:99], v6 offset:5184
v_mfma_f32_16x16x32_bf16 v[244:247], v[60:63], v[24:27], v[244:247]
v_mfma_f32_16x16x32_bf16 v[248:251], v[60:63], v[28:31], v[248:251]
s_add_u32 m0, s53, 12288
s_nop 0
v_mfma_f32_16x16x32_bf16 v[252:255], v[60:63], v[68:71], v[252:255]
s_waitcnt lgkmcnt(2)
v_mfma_f32_16x16x32_bf16 v[112:115], v[44:47], v[88:91], v[112:115]
ds_read_b128 v[72:75], v6 offset:6208
v_mfma_f32_16x16x32_bf16 v[144:147], v[64:67], v[88:91], v[144:147]
v_mfma_f32_16x16x32_bf16 v[176:179], v[84:87], v[88:91], v[176:179]
v_mfma_f32_16x16x32_bf16 v[208:211], v[40:43], v[88:91], v[208:211]
v_mfma_f32_16x16x32_bf16 v[116:119], v[44:47], v[48:51], v[116:119]
ds_read_b128 v[76:79], v6 offset:7232
v_mfma_f32_16x16x32_bf16 v[148:151], v[64:67], v[48:51], v[148:151]
v_mfma_f32_16x16x32_bf16 v[180:183], v[84:87], v[48:51], v[180:183]
buffer_load_dwordx4 v8, s[16:19], s44 offen offset:0  lds
v_mfma_f32_16x16x32_bf16 v[212:215], v[40:43], v[48:51], v[212:215]
v_mfma_f32_16x16x32_bf16 v[120:123], v[44:47], v[52:55], v[120:123]
ds_read_b64_tr_b16 v[36:37], v7 offset:0
ds_read_b64_tr_b16 v[38:39], v7 offset:256
v_mfma_f32_16x16x32_bf16 v[152:155], v[64:67], v[52:55], v[152:155]
v_mfma_f32_16x16x32_bf16 v[184:187], v[84:87], v[52:55], v[184:187]
v_mfma_f32_16x16x32_bf16 v[216:219], v[40:43], v[52:55], v[216:219]
v_mfma_f32_16x16x32_bf16 v[124:127], v[44:47], v[92:95], v[124:127]
ds_read_b128 v[80:83], v6 offset:8256
v_mfma_f32_16x16x32_bf16 v[156:159], v[64:67], v[92:95], v[156:159]
ds_read_b128 v[12:15], v5 offset:16384
v_mfma_f32_16x16x32_bf16 v[188:191], v[84:87], v[92:95], v[188:191]
buffer_load_dwordx4 v9, s[16:19], s45 offen offset:1024  lds
v_mfma_f32_16x16x32_bf16 v[220:223], v[40:43], v[92:95], v[220:223]
ds_read_b128 v[20:23], v5 offset:18432
s_waitcnt lgkmcnt(5)
v_mfma_f32_16x16x32_bf16 v[128:131], v[44:47], v[56:59], v[128:131]
ds_read_b128 v[32:35], v5 offset:20480
v_mfma_f32_16x16x32_bf16 v[160:163], v[64:67], v[56:59], v[160:163]
ds_read_b128 v[16:19], v5 offset:22528
v_mfma_f32_16x16x32_bf16 v[192:195], v[84:87], v[56:59], v[192:195]
ds_read_b128 v[24:27], v6 offset:9280
v_mfma_f32_16x16x32_bf16 v[224:227], v[40:43], v[56:59], v[224:227]
v_mfma_f32_16x16x32_bf16 v[132:135], v[44:47], v[96:99], v[132:135]
ds_read_b128 v[28:31], v6 offset:10304
v_mfma_f32_16x16x32_bf16 v[164:167], v[64:67], v[96:99], v[164:167]
v_mfma_f32_16x16x32_bf16 v[196:199], v[84:87], v[96:99], v[196:199]
buffer_load_dwordx4 v8, s[16:19], s46 offen offset:2048  lds
v_mfma_f32_16x16x32_bf16 v[228:231], v[40:43], v[96:99], v[228:231]
v_mfma_f32_16x16x32_bf16 v[136:139], v[44:47], v[72:75], v[136:139]
ds_read_b128 v[60:63], v6 offset:11328
v_mfma_f32_16x16x32_bf16 v[168:171], v[64:67], v[72:75], v[168:171]
v_mfma_f32_16x16x32_bf16 v[200:203], v[84:87], v[72:75], v[200:203]
v_mfma_f32_16x16x32_bf16 v[232:235], v[40:43], v[72:75], v[232:235]
v_mfma_f32_16x16x32_bf16 v[140:143], v[44:47], v[76:79], v[140:143]
ds_read_b128 v[68:71], v6 offset:12416
v_mfma_f32_16x16x32_bf16 v[172:175], v[64:67], v[76:79], v[172:175]
v_mfma_f32_16x16x32_bf16 v[204:207], v[84:87], v[76:79], v[204:207]
buffer_load_dwordx4 v9, s[16:19], s47 offen offset:3072  lds
v_mfma_f32_16x16x32_bf16 v[236:239], v[40:43], v[76:79], v[236:239]
s_waitcnt lgkmcnt(2)
v_mfma_f32_16x16x32_bf16 v[240:243], v[36:39], v[44:47], v[240:243]
ds_read_b128 v[88:91], v6 offset:13440
v_mfma_f32_16x16x32_bf16 v[244:247], v[36:39], v[64:67], v[244:247]
v_mfma_f32_16x16x32_bf16 v[248:251], v[36:39], v[84:87], v[248:251]
v_mfma_f32_16x16x32_bf16 v[252:255], v[36:39], v[40:43], v[252:255]
v_mfma_f32_16x16x32_bf16 v[112:115], v[12:15], v[80:83], v[112:115]
ds_read_b128 v[48:51], v6 offset:14464
v_mfma_f32_16x16x32_bf16 v[144:147], v[20:23], v[80:83], v[144:147]
v_mfma_f32_16x16x32_bf16 v[176:179], v[32:35], v[80:83], v[176:179]
s_add_u32 s37, s37, 1
s_cmp_eq_u32 s37, 9
s_cselect_b32 s37, 0, s37
s_lshl_b32 s51, s37, 7
s_add_u32 s16, s4, s51
s_addc_u32 s17, s5, 0
v_mfma_f32_16x16x32_bf16 v[208:211], v[16:19], v[80:83], v[208:211]
v_mfma_f32_16x16x32_bf16 v[116:119], v[12:15], v[24:27], v[116:119]
ds_read_b128 v[52:55], v6 offset:15488
v_mfma_f32_16x16x32_bf16 v[148:151], v[20:23], v[24:27], v[148:151]
v_mfma_f32_16x16x32_bf16 v[180:183], v[32:35], v[24:27], v[180:183]
v_mfma_f32_16x16x32_bf16 v[212:215], v[16:19], v[24:27], v[212:215]
v_mfma_f32_16x16x32_bf16 v[120:123], v[12:15], v[28:31], v[120:123]
ds_read_b64_tr_b16 v[92:93], v7 offset:1024
ds_read_b64_tr_b16 v[94:95], v7 offset:1280
v_mfma_f32_16x16x32_bf16 v[152:155], v[20:23], v[28:31], v[152:155]
v_mfma_f32_16x16x32_bf16 v[184:187], v[32:35], v[28:31], v[184:187]
s_add_u32 m0, s53, 16384
s_nop 0
v_mfma_f32_16x16x32_bf16 v[216:219], v[16:19], v[28:31], v[216:219]
s_waitcnt lgkmcnt(3)
v_mfma_f32_16x16x32_bf16 v[124:127], v[12:15], v[60:63], v[124:127]
s_waitcnt vmcnt(12)
ds_read_b128 v[56:59], v4 offset:0
v_mfma_f32_16x16x32_bf16 v[156:159], v[20:23], v[60:63], v[156:159]
ds_read_b128 v[96:99], v4 offset:2048
v_mfma_f32_16x16x32_bf16 v[188:191], v[32:35], v[60:63], v[188:191]
s_waitcnt vmcnt(8)
ds_read_b128 v[72:75], v4 offset:4096
v_mfma_f32_16x16x32_bf16 v[220:223], v[16:19], v[60:63], v[220:223]
ds_read_b128 v[76:79], v4 offset:6144
v_mfma_f32_16x16x32_bf16 v[128:131], v[12:15], v[68:71], v[128:131]
s_waitcnt lgkmcnt(4)
s_barrier
ds_read_b128 v[44:47], v6 offset:18560
v_mfma_f32_16x16x32_bf16 v[160:163], v[20:23], v[68:71], v[160:163]
ds_read_b128 v[64:67], v6 offset:19584
v_mfma_f32_16x16x32_bf16 v[192:195], v[32:35], v[68:71], v[192:195]
buffer_load_dwordx4 v8, s[16:19], 0 offen offset:0  lds
v_mfma_f32_16x16x32_bf16 v[224:227], v[16:19], v[68:71], v[224:227]
v_mfma_f32_16x16x32_bf16 v[132:135], v[12:15], v[88:91], v[132:135]
ds_read_b128 v[84:87], v6 offset:20608
v_mfma_f32_16x16x32_bf16 v[164:167], v[20:23], v[88:91], v[164:167]
v_mfma_f32_16x16x32_bf16 v[196:199], v[32:35], v[88:91], v[196:199]
v_mfma_f32_16x16x32_bf16 v[228:231], v[16:19], v[88:91], v[228:231]
v_mfma_f32_16x16x32_bf16 v[136:139], v[12:15], v[48:51], v[136:139]
ds_read_b128 v[36:39], v6 offset:21632
v_mfma_f32_16x16x32_bf16 v[168:171], v[20:23], v[48:51], v[168:171]
v_mfma_f32_16x16x32_bf16 v[200:203], v[32:35], v[48:51], v[200:203]
buffer_load_dwordx4 v9, s[16:19], s41 offen offset:1024  lds
v_mfma_f32_16x16x32_bf16 v[232:235], v[16:19], v[48:51], v[232:235]
v_mfma_f32_16x16x32_bf16 v[140:143], v[12:15], v[52:55], v[140:143]
ds_read_b128 v[40:43], v6 offset:22720
v_mfma_f32_16x16x32_bf16 v[172:175], v[20:23], v[52:55], v[172:175]
v_mfma_f32_16x16x32_bf16 v[204:207], v[32:35], v[52:55], v[204:207]
v_mfma_f32_16x16x32_bf16 v[236:239], v[16:19], v[52:55], v[236:239]
v_mfma_f32_16x16x32_bf16 v[240:243], v[92:95], v[12:15], v[240:243]
ds_read_b128 v[80:83], v6 offset:23744
v_mfma_f32_16x16x32_bf16 v[244:247], v[92:95], v[20:23], v[244:247]
v_mfma_f32_16x16x32_bf16 v[248:251], v[92:95], v[32:35], v[248:251]
buffer_load_dwordx4 v8, s[16:19], s42 offen offset:2048  lds
v_mfma_f32_16x16x32_bf16 v[252:255], v[92:95], v[16:19], v[252:255]
s_waitcnt lgkmcnt(2)
v_mfma_f32_16x16x32_bf16 v[112:115], v[56:59], v[44:47], v[112:115]
ds_read_b128 v[24:27], v6 offset:24768
v_mfma_f32_16x16x32_bf16 v[144:147], v[96:99], v[44:47], v[144:147]
v_mfma_f32_16x16x32_bf16 v[176:179], v[72:75], v[44:47], v[176:179]
v_mfma_f32_16x16x32_bf16 v[208:211], v[76:79], v[44:47], v[208:211]
v_mfma_f32_16x16x32_bf16 v[116:119], v[56:59], v[64:67], v[116:119]
ds_read_b128 v[28:31], v6 offset:25792
v_mfma_f32_16x16x32_bf16 v[148:151], v[96:99], v[64:67], v[148:151]
v_mfma_f32_16x16x32_bf16 v[180:183], v[72:75], v[64:67], v[180:183]
buffer_load_dwordx4 v9, s[16:19], s43 offen offset:3072  lds
v_mfma_f32_16x16x32_bf16 v[212:215], v[76:79], v[64:67], v[212:215]
v_mfma_f32_16x16x32_bf16 v[120:123], v[56:59], v[84:87], v[120:123]
ds_read_b64_tr_b16 v[60:61], v7 offset:18560
ds_read_b64_tr_b16 v[62:63], v7 offset:18816
v_mfma_f32_16x16x32_bf16 v[152:155], v[96:99], v[84:87], v[152:155]
v_mfma_f32_16x16x32_bf16 v[184:187], v[72:75], v[84:87], v[184:187]
v_mfma_f32_16x16x32_bf16 v[216:219], v[76:79], v[84:87], v[216:219]
s_add_u32 m0, s53, 20480
s_nop 0
v_mfma_f32_16x16x32_bf16 v[124:127], v[56:59], v[36:39], v[124:127]
ds_read_b128 v[68:71], v6 offset:26816
v_mfma_f32_16x16x32_bf16 v[156:159], v[96:99], v[36:39], v[156:159]
ds_read_b128 v[88:91], v5 offset:0
v_mfma_f32_16x16x32_bf16 v[188:191], v[72:75], v[36:39], v[188:191]
ds_read_b128 v[48:51], v5 offset:2048
v_mfma_f32_16x16x32_bf16 v[220:223], v[76:79], v[36:39], v[220:223]
ds_read_b128 v[52:55], v5 offset:4096
s_waitcnt lgkmcnt(6)
v_mfma_f32_16x16x32_bf16 v[128:131], v[56:59], v[40:43], v[128:131]
ds_read_b128 v[12:15], v5 offset:6144
v_mfma_f32_16x16x32_bf16 v[160:163], v[96:99], v[40:43], v[160:163]
ds_read_b128 v[20:23], v6 offset:27840
v_mfma_f32_16x16x32_bf16 v[192:195], v[72:75], v[40:43], v[192:195]
v_mfma_f32_16x16x32_bf16 v[224:227], v[76:79], v[40:43], v[224:227]
buffer_load_dwordx4 v8, s[16:19], s44 offen offset:0  lds
v_mfma_f32_16x16x32_bf16 v[132:135], v[56:59], v[80:83], v[132:135]
ds_read_b128 v[32:35], v6 offset:28864
v_mfma_f32_16x16x32_bf16 v[164:167], v[96:99], v[80:83], v[164:167]
v_mfma_f32_16x16x32_bf16 v[196:199], v[72:75], v[80:83], v[196:199]
v_mfma_f32_16x16x32_bf16 v[228:231], v[76:79], v[80:83], v[228:231]
v_mfma_f32_16x16x32_bf16 v[136:139], v[56:59], v[24:27], v[136:139]
ds_read_b128 v[92:95], v6 offset:29888
v_mfma_f32_16x16x32_bf16 v[168:171], v[96:99], v[24:27], v[168:171]
v_mfma_f32_16x16x32_bf16 v[200:203], v[72:75], v[24:27], v[200:203]
v_mfma_f32_16x16x32_bf16 v[232:235], v[76:79], v[24:27], v[232:235]
buffer_load_dwordx4 v9, s[16:19], s45 offen offset:1024  lds
v_mfma_f32_16x16x32_bf16 v[140:143], v[56:59], v[28:31], v[140:143]
ds_read_b128 v[16:19], v6 offset:30976
v_mfma_f32_16x16x32_bf16 v[172:175], v[96:99], v[28:31], v[172:175]
v_mfma_f32_16x16x32_bf16 v[204:207], v[72:75], v[28:31], v[204:207]
v_mfma_f32_16x16x32_bf16 v[236:239], v[76:79], v[28:31], v[236:239]
s_waitcnt lgkmcnt(2)
v_mfma_f32_16x16x32_bf16 v[240:243], v[60:63], v[56:59], v[240:243]
ds_read_b128 v[44:47], v6 offset:32000
v_mfma_f32_16x16x32_bf16 v[244:247], v[60:63], v[96:99], v[244:247]
v_mfma_f32_16x16x32_bf16 v[248:251], v[60:63], v[72:75], v[248:251]
v_mfma_f32_16x16x32_bf16 v[252:255], v[60:63], v[76:79], v[252:255]
buffer_load_dwordx4 v8, s[16:19], s46 offen offset:2048  lds
v_mfma_f32_16x16x32_bf16 v[112:115], v[88:91], v[68:71], v[112:115]
ds_read_b128 v[64:67], v6 offset:33024
v_mfma_f32_16x16x32_bf16 v[144:147], v[48:51], v[68:71], v[144:147]
v_mfma_f32_16x16x32_bf16 v[176:179], v[52:55], v[68:71], v[176:179]
v_mfma_f32_16x16x32_bf16 v[208:211], v[12:15], v[68:71], v[208:211]
v_mfma_f32_16x16x32_bf16 v[116:119], v[88:91], v[20:23], v[116:119]
ds_read_b128 v[84:87], v6 offset:34048
v_mfma_f32_16x16x32_bf16 v[148:151], v[48:51], v[20:23], v[148:151]
v_mfma_f32_16x16x32_bf16 v[180:183], v[52:55], v[20:23], v[180:183]
v_mfma_f32_16x16x32_bf16 v[212:215], v[12:15], v[20:23], v[212:215]
buffer_load_dwordx4 v9, s[16:19], s47 offen offset:3072  lds
v_mfma_f32_16x16x32_bf16 v[120:123], v[88:91], v[32:35], v[120:123]
ds_read_b64_tr_b16 v[36:37], v7 offset:19584
ds_read_b64_tr_b16 v[38:39], v7 offset:19840
v_mfma_f32_16x16x32_bf16 v[152:155], v[48:51], v[32:35], v[152:155]
v_mfma_f32_16x16x32_bf16 v[184:187], v[52:55], v[32:35], v[184:187]
v_mfma_f32_16x16x32_bf16 v[216:219], v[12:15], v[32:35], v[216:219]
s_waitcnt lgkmcnt(3)
v_mfma_f32_16x16x32_bf16 v[124:127], v[88:91], v[92:95], v[124:127]
s_waitcnt vmcnt(12)
ds_read_b128 v[40:43], v4 offset:8192
v_mfma_f32_16x16x32_bf16 v[156:159], v[48:51], v[92:95], v[156:159]
ds_read_b128 v[80:83], v4 offset:10240
v_mfma_f32_16x16x32_bf16 v[188:191], v[52:55], v[92:95], v[188:191]
s_waitcnt vmcnt(8)
ds_read_b128 v[24:27], v4 offset:12288
v_mfma_f32_16x16x32_bf16 v[220:223], v[12:15], v[92:95], v[220:223]
s_add_u32 s37, s37, 1
s_cmp_eq_u32 s37, 9
s_cselect_b32 s37, 0, s37
s_lshl_b32 s51, s37, 7
s_add_u32 s16, s4, s51
s_addc_u32 s17, s5, 0
v_mfma_f32_16x16x32_bf16 v[128:131], v[88:91], v[16:19], v[128:131]
s_waitcnt lgkmcnt(3)
s_barrier
ds_read_b128 v[28:31], v6 offset:0
v_mfma_f32_16x16x32_bf16 v[160:163], v[48:51], v[16:19], v[160:163]
ds_read_b128 v[56:59], v4 offset:14336
v_mfma_f32_16x16x32_bf16 v[192:195], v[52:55], v[16:19], v[192:195]
ds_read_b128 v[96:99], v6 offset:1024
v_mfma_f32_16x16x32_bf16 v[224:227], v[12:15], v[16:19], v[224:227]
v_mfma_f32_16x16x32_bf16 v[132:135], v[88:91], v[44:47], v[132:135]
ds_read_b128 v[72:75], v6 offset:2048
v_mfma_f32_16x16x32_bf16 v[164:167], v[48:51], v[44:47], v[164:167]
v_mfma_f32_16x16x32_bf16 v[196:199], v[52:55], v[44:47], v[196:199]
v_mfma_f32_16x16x32_bf16 v[228:231], v[12:15], v[44:47], v[228:231]
s_add_u32 m0, s53, 0
s_nop 0
v_mfma_f32_16x16x32_bf16 v[136:139], v[88:91], v[64:67], v[136:139]
ds_read_b128 v[60:63], v6 offset:3072
v_mfma_f32_16x16x32_bf16 v[168:171], v[48:51], v[64:67], v[168:171]
v_mfma_f32_16x16x32_bf16 v[200:203], v[52:55], v[64:67], v[200:203]
v_mfma_f32_16x16x32_bf16 v[232:235], v[12:15], v[64:67], v[232:235]
v_mfma_f32_16x16x32_bf16 v[140:143], v[88:91], v[84:87], v[140:143]
ds_read_b128 v[76:79], v6 offset:4160
v_mfma_f32_16x16x32_bf16 v[172:175], v[48:51], v[84:87], v[172:175]
v_mfma_f32_16x16x32_bf16 v[204:207], v[52:55], v[84:87], v[204:207]
v_mfma_f32_16x16x32_bf16 v[236:239], v[12:15], v[84:87], v[236:239]
buffer_load_dwordx4 v8, s[16:19], 0 offen offset:0  lds
v_mfma_f32_16x16x32_bf16 v[240:243], v[36:39], v[88:91], v[240:243]
ds_read_b128 v[68:71], v6 offset:5184
v_mfma_f32_16x16x32_bf16 v[244:247], v[36:39], v[48:51], v[244:247]
v_mfma_f32_16x16x32_bf16 v[248:251], v[36:39], v[52:55], v[248:251]
v_mfma_f32_16x16x32_bf16 v[252:255], v[36:39], v[12:15], v[252:255]
s_waitcnt lgkmcnt(2)
v_mfma_f32_16x16x32_bf16 v[112:115], v[40:43], v[28:31], v[112:115]
ds_read_b128 v[20:23], v6 offset:6208
v_mfma_f32_16x16x32_bf16 v[144:147], v[80:83], v[28:31], v[144:147]
v_mfma_f32_16x16x32_bf16 v[176:179], v[24:27], v[28:31], v[176:179]
v_mfma_f32_16x16x32_bf16 v[208:211], v[56:59], v[28:31], v[208:211]
buffer_load_dwordx4 v9, s[16:19], s41 offen offset:1024  lds
v_mfma_f32_16x16x32_bf16 v[116:119], v[40:43], v[96:99], v[116:119]
ds_read_b128 v[32:35], v6 offset:7232
v_mfma_f32_16x16x32_bf16 v[148:151], v[80:83], v[96:99], v[148:151]
v_mfma_f32_16x16x32_bf16 v[180:183], v[24:27], v[96:99], v[180:183]
v_mfma_f32_16x16x32_bf16 v[212:215], v[56:59], v[96:99], v[212:215]
v_mfma_f32_16x16x32_bf16 v[120:123], v[40:43], v[72:75], v[120:123]
ds_read_b64_tr_b16 v[92:93], v7 offset:0
ds_read_b64_tr_b16 v[94:95], v7 offset:256
v_mfma_f32_16x16x32_bf16 v[152:155], v[80:83], v[72:75], v[152:155]
v_mfma_f32_16x16x32_bf16 v[184:187], v[24:27], v[72:75], v[184:187]
v_mfma_f32_16x16x32_bf16 v[216:219], v[56:59], v[72:75], v[216:219]
buffer_load_dwordx4 v8, s[16:19], s42 offen offset:2048  lds
v_mfma_f32_16x16x32_bf16 v[124:127], v[40:43], v[60:63], v[124:127]
ds_read_b128 v[16:19], v6 offset:8256
v_mfma_f32_16x16x32_bf16 v[156:159], v[80:83], v[60:63], v[156:159]
ds_read_b128 v[44:47], v5 offset:8192
v_mfma_f32_16x16x32_bf16 v[188:191], v[24:27], v[60:63], v[188:191]
ds_read_b128 v[64:67], v5 offset:10240
v_mfma_f32_16x16x32_bf16 v[220:223], v[56:59], v[60:63], v[220:223]
ds_read_b128 v[84:87], v5 offset:12288
s_waitcnt lgkmcnt(6)
v_mfma_f32_16x16x32_bf16 v[128:131], v[40:43], v[76:79], v[128:131]
ds_read_b128 v[88:91], v5 offset:14336
v_mfma_f32_16x16x32_bf16 v[160:163], v[80:83], v[76:79], v[160:163]
ds_read_b128 v[48:51], v6 offset:9280
v_mfma_f32_16x16x32_bf16 v[192:195], v[24:27], v[76:79], v[192:195]
v_mfma_f32_16x16x32_bf16 v[224:227], v[56:59], v[76:79], v[224:227]
buffer_load_dwordx4 v9, s[16:19], s43 offen offset:3072  lds
v_mfma_f32_16x16x32_bf16 v[132:135], v[40:43], v[68:71], v[132:135]
ds_read_b128 v[52:55], v6 offset:10304
v_mfma_f32_16x16x32_bf16 v[164:167], v[80:83], v[68:71], v[164:167]
v_mfma_f32_16x16x32_bf16 v[196:199], v[24:27], v[68:71], v[196:199]
v_mfma_f32_16x16x32_bf16 v[228:231], v[56:59], v[68:71], v[228:231]
v_mfma_f32_16x16x32_bf16 v[136:139], v[40:43], v[20:23], v[136:139]
s_add_u32 m0, s53, 4096
s_nop 0
v_mfma_f32_16x16x32_bf16 v[168:171], v[80:83], v[20:23], v[168:171]
ds_read_b128 v[36:39], v6 offset:11328
v_mfma_f32_16x16x32_bf16 v[200:203], v[24:27], v[20:23], v[200:203]
v_mfma_f32_16x16x32_bf16 v[232:235], v[56:59], v[20:23], v[232:235]
v_mfma_f32_16x16x32_bf16 v[140:143], v[40:43], v[32:35], v[140:143]
ds_read_b128 v[12:15], v6 offset:12416
v_mfma_f32_16x16x32_bf16 v[172:175], v[80:83], v[32:35], v[172:175]
v_mfma_f32_16x16x32_bf16 v[204:207], v[24:27], v[32:35], v[204:207]
v_mfma_f32_16x16x32_bf16 v[236:239], v[56:59], v[32:35], v[236:239]
s_waitcnt lgkmcnt(2)
v_mfma_f32_16x16x32_bf16 v[240:243], v[92:95], v[40:43], v[240:243]
buffer_load_dwordx4 v8, s[16:19], s44 offen offset:0  lds
v_mfma_f32_16x16x32_bf16 v[244:247], v[92:95], v[80:83], v[244:247]
ds_read_b128 v[28:31], v6 offset:13440
v_mfma_f32_16x16x32_bf16 v[248:251], v[92:95], v[24:27], v[248:251]
v_mfma_f32_16x16x32_bf16 v[252:255], v[92:95], v[56:59], v[252:255]
v_mfma_f32_16x16x32_bf16 v[112:115], v[44:47], v[16:19], v[112:115]
ds_read_b128 v[96:99], v6 offset:14464
v_mfma_f32_16x16x32_bf16 v[144:147], v[64:67], v[16:19], v[144:147]
v_mfma_f32_16x16x32_bf16 v[176:179], v[84:87], v[16:19], v[176:179]
v_mfma_f32_16x16x32_bf16 v[208:211], v[88:91], v[16:19], v[208:211]
v_mfma_f32_16x16x32_bf16 v[116:119], v[44:47], v[48:51], v[116:119]
buffer_load_dwordx4 v9, s[16:19], s45 offen offset:1024  lds
v_mfma_f32_16x16x32_bf16 v[148:151], v[64:67], v[48:51], v[148:151]
ds_read_b128 v[72:75], v6 offset:15488
v_mfma_f32_16x16x32_bf16 v[180:183], v[84:87], v[48:51], v[180:183]
v_mfma_f32_16x16x32_bf16 v[212:215], v[88:91], v[48:51], v[212:215]
v_mfma_f32_16x16x32_bf16 v[120:123], v[44:47], v[52:55], v[120:123]
ds_read_b64_tr_b16 v[60:61], v7 offset:1024
ds_read_b64_tr_b16 v[62:63], v7 offset:1280
v_mfma_f32_16x16x32_bf16 v[152:155], v[64:67], v[52:55], v[152:155]
v_mfma_f32_16x16x32_bf16 v[184:187], v[84:87], v[52:55], v[184:187]
v_mfma_f32_16x16x32_bf16 v[216:219], v[88:91], v[52:55], v[216:219]
s_waitcnt lgkmcnt(3)
v_mfma_f32_16x16x32_bf16 v[124:127], v[44:47], v[36:39], v[124:127]
buffer_load_dwordx4 v8, s[16:19], s46 offen offset:2048  lds
v_mfma_f32_16x16x32_bf16 v[156:159], v[64:67], v[36:39], v[156:159]
s_waitcnt vmcnt(11)
ds_read_b128 v[76:79], v4 offset:16384
v_mfma_f32_16x16x32_bf16 v[188:191], v[84:87], v[36:39], v[188:191]
ds_read_b128 v[68:71], v4 offset:18432
v_mfma_f32_16x16x32_bf16 v[220:223], v[88:91], v[36:39], v[220:223]
s_waitcnt vmcnt(7)
ds_read_b128 v[20:23], v4 offset:20480
v_mfma_f32_16x16x32_bf16 v[128:131], v[44:47], v[12:15], v[128:131]
s_waitcnt lgkmcnt(3)
s_barrier
ds_read_b128 v[32:35], v6 offset:18560
v_mfma_f32_16x16x32_bf16 v[160:163], v[64:67], v[12:15], v[160:163]
ds_read_b128 v[40:43], v4 offset:22528
v_mfma_f32_16x16x32_bf16 v[192:195], v[84:87], v[12:15], v[192:195]
ds_read_b128 v[80:83], v6 offset:19584
v_mfma_f32_16x16x32_bf16 v[224:227], v[88:91], v[12:15], v[224:227]
v_mfma_f32_16x16x32_bf16 v[132:135], v[44:47], v[28:31], v[132:135]
buffer_load_dwordx4 v9, s[16:19], s47 offen offset:3072  lds
v_mfma_f32_16x16x32_bf16 v[164:167], v[64:67], v[28:31], v[164:167]
ds_read_b128 v[24:27], v6 offset:20608
v_mfma_f32_16x16x32_bf16 v[196:199], v[84:87], v[28:31], v[196:199]
v_mfma_f32_16x16x32_bf16 v[228:231], v[88:91], v[28:31], v[228:231]
v_mfma_f32_16x16x32_bf16 v[136:139], v[44:47], v[96:99], v[136:139]
ds_read_b128 v[92:95], v6 offset:21632
v_mfma_f32_16x16x32_bf16 v[168:171], v[64:67], v[96:99], v[168:171]
v_mfma_f32_16x16x32_bf16 v[200:203], v[84:87], v[96:99], v[200:203]
v_mfma_f32_16x16x32_bf16 v[232:235], v[88:91], v[96:99], v[232:235]
v_mfma_f32_16x16x32_bf16 v[140:143], v[44:47], v[72:75], v[140:143]
s_add_u32 s37, s37, 1
s_cmp_eq_u32 s37, 9
s_cselect_b32 s37, 0, s37
s_lshl_b32 s51, s37, 7
s_add_u32 s16, s4, s51
s_addc_u32 s17, s5, 0
v_mfma_f32_16x16x32_bf16 v[172:175], v[64:67], v[72:75], v[172:175]
ds_read_b128 v[56:59], v6 offset:22720
v_mfma_f32_16x16x32_bf16 v[204:207], v[84:87], v[72:75], v[204:207]
v_mfma_f32_16x16x32_bf16 v[236:239], v[88:91], v[72:75], v[236:239]
v_mfma_f32_16x16x32_bf16 v[240:243], v[60:63], v[44:47], v[240:243]
ds_read_b128 v[16:19], v6 offset:23744
v_mfma_f32_16x16x32_bf16 v[244:247], v[60:63], v[64:67], v[244:247]
v_mfma_f32_16x16x32_bf16 v[248:251], v[60:63], v[84:87], v[248:251]
v_mfma_f32_16x16x32_bf16 v[252:255], v[60:63], v[88:91], v[252:255]
s_waitcnt lgkmcnt(2)
v_mfma_f32_16x16x32_bf16 v[112:115], v[76:79], v[32:35], v[112:115]
s_add_u32 m0, s53, 8192
s_nop 0
v_mfma_f32_16x16x32_bf16 v[144:147], v[68:71], v[32:35], v[144:147]
ds_read_b128 v[48:51], v6 offset:24768
v_mfma_f32_16x16x32_bf16 v[176:179], v[20:23], v[32:35], v[176:179]
v_mfma_f32_16x16x32_bf16 v[208:211], v[40:43], v[32:35], v[208:211]
v_mfma_f32_16x16x32_bf16 v[116:119], v[76:79], v[80:83], v[116:119]
ds_read_b128 v[52:55], v6 offset:25792
v_mfma_f32_16x16x32_bf16 v[148:151], v[68:71], v[80:83], v[148:151]
v_mfma_f32_16x16x32_bf16 v[180:183], v[20:23], v[80:83], v[180:183]
v_mfma_f32_16x16x32_bf16 v[212:215], v[40:43], v[80:83], v[212:215]
v_mfma_f32_16x16x32_bf16 v[120:123], v[76:79], v[24:27], v[120:123]
buffer_load_dwordx4 v8, s[16:19], 0 offen offset:0  lds
v_mfma_f32_16x16x32_bf16 v[152:155], v[68:71], v[24:27], v[152:155]
ds_read_b64_tr_b16 v[36:37], v7 offset:18560
ds_read_b64_tr_b16 v[38:39], v7 offset:18816
v_mfma_f32_16x16x32_bf16 v[184:187], v[20:23], v[24:27], v[184:187]
v_mfma_f32_16x16x32_bf16 v[216:219], v[40:43], v[24:27], v[216:219]
v_mfma_f32_16x16x32_bf16 v[124:127], v[76:79], v[92:95], v[124:127]
ds_read_b128 v[12:15], v6 offset:26816
v_mfma_f32_16x16x32_bf16 v[156:159], v[68:71], v[92:95], v[156:159]
ds_read_b128 v[28:31], v5 offset:16384
v_mfma_f32_16x16x32_bf16 v[188:191], v[20:23], v[92:95], v[188:191]
ds_read_b128 v[96:99], v5 offset:18432
v_mfma_f32_16x16x32_bf16 v[220:223], v[40:43], v[92:95], v[220:223]
ds_read_b128 v[72:75], v5 offset:20480
s_waitcnt lgkmcnt(6)
v_mfma_f32_16x16x32_bf16 v[128:131], v[76:79], v[56:59], v[128:131]
buffer_load_dwordx4 v9, s[16:19], s41 offen offset:1024  lds
v_mfma_f32_16x16x32_bf16 v[160:163], v[68:71], v[56:59], v[160:163]
ds_read_b128 v[44:47], v5 offset:22528
v_mfma_f32_16x16x32_bf16 v[192:195], v[20:23], v[56:59], v[192:195]
ds_read_b128 v[64:67], v6 offset:27840
v_mfma_f32_16x16x32_bf16 v[224:227], v[40:43], v[56:59], v[224:227]
v_mfma_f32_16x16x32_bf16 v[132:135], v[76:79], v[16:19], v[132:135]
ds_read_b128 v[84:87], v6 offset:28864
v_mfma_f32_16x16x32_bf16 v[164:167], v[68:71], v[16:19], v[164:167]
v_mfma_f32_16x16x32_bf16 v[196:199], v[20:23], v[16:19], v[196:199]
v_mfma_f32_16x16x32_bf16 v[228:231], v[40:43], v[16:19], v[228:231]
v_mfma_f32_16x16x32_bf16 v[136:139], v[76:79], v[48:51], v[136:139]
buffer_load_dwordx4 v8, s[16:19], s42 offen offset:2048  lds
v_mfma_f32_16x16x32_bf16 v[168:171], v[68:71], v[48:51], v[168:171]
ds_read_b128 v[60:63], v6 offset:29888
v_mfma_f32_16x16x32_bf16 v[200:203], v[20:23], v[48:51], v[200:203]
v_mfma_f32_16x16x32_bf16 v[232:235], v[40:43], v[48:51], v[232:235]
v_mfma_f32_16x16x32_bf16 v[140:143], v[76:79], v[52:55], v[140:143]
ds_read_b128 v[88:91], v6 offset:30976
v_mfma_f32_16x16x32_bf16 v[172:175], v[68:71], v[52:55], v[172:175]
v_mfma_f32_16x16x32_bf16 v[204:207], v[20:23], v[52:55], v[204:207]
v_mfma_f32_16x16x32_bf16 v[236:239], v[40:43], v[52:55], v[236:239]
s_waitcnt lgkmcnt(2)
v_mfma_f32_16x16x32_bf16 v[240:243], v[36:39], v[76:79], v[240:243]
buffer_load_dwordx4 v9, s[16:19], s43 offen offset:3072  lds
v_mfma_f32_16x16x32_bf16 v[244:247], v[36:39], v[68:71], v[244:247]
ds_read_b128 v[32:35], v6 offset:32000
v_mfma_f32_16x16x32_bf16 v[248:251], v[36:39], v[20:23], v[248:251]
v_mfma_f32_16x16x32_bf16 v[252:255], v[36:39], v[40:43], v[252:255]
v_mfma_f32_16x16x32_bf16 v[112:115], v[28:31], v[12:15], v[112:115]
ds_read_b128 v[80:83], v6 offset:33024
v_mfma_f32_16x16x32_bf16 v[144:147], v[96:99], v[12:15], v[144:147]
s_add_u32 m0, s53, 12288
s_nop 0
v_mfma_f32_16x16x32_bf16 v[176:179], v[72:75], v[12:15], v[176:179]
v_mfma_f32_16x16x32_bf16 v[208:211], v[44:47], v[12:15], v[208:211]
v_mfma_f32_16x16x32_bf16 v[116:119], v[28:31], v[64:67], v[116:119]
ds_read_b128 v[24:27], v6 offset:34048
v_mfma_f32_16x16x32_bf16 v[148:151], v[96:99], v[64:67], v[148:151]
v_mfma_f32_16x16x32_bf16 v[180:183], v[72:75], v[64:67], v[180:183]
v_mfma_f32_16x16x32_bf16 v[212:215], v[44:47], v[64:67], v[212:215]
v_mfma_f32_16x16x32_bf16 v[120:123], v[28:31], v[84:87], v[120:123]
ds_read_b64_tr_b16 v[92:93], v7 offset:19584
ds_read_b64_tr_b16 v[94:95], v7 offset:19840
v_mfma_f32_16x16x32_bf16 v[152:155], v[96:99], v[84:87], v[152:155]
buffer_load_dwordx4 v8, s[16:19], s44 offen offset:0  lds
v_mfma_f32_16x16x32_bf16 v[184:187], v[72:75], v[84:87], v[184:187]
v_mfma_f32_16x16x32_bf16 v[216:219], v[44:47], v[84:87], v[216:219]
s_waitcnt lgkmcnt(3)
v_mfma_f32_16x16x32_bf16 v[124:127], v[28:31], v[60:63], v[124:127]
s_waitcnt vmcnt(9)
ds_read_b128 v[56:59], v4 offset:0
v_mfma_f32_16x16x32_bf16 v[156:159], v[96:99], v[60:63], v[156:159]
ds_read_b128 v[16:19], v4 offset:2048
v_mfma_f32_16x16x32_bf16 v[188:191], v[72:75], v[60:63], v[188:191]
v_mfma_f32_16x16x32_bf16 v[220:223], v[44:47], v[60:63], v[220:223]
v_mfma_f32_16x16x32_bf16 v[128:131], v[28:31], v[88:91], v[128:131]
s_waitcnt lgkmcnt(2)
s_barrier
ds_read_b128 v[48:51], v6 offset:0
v_mfma_f32_16x16x32_bf16 v[160:163], v[96:99], v[88:91], v[160:163]
buffer_load_dwordx4 v9, s[16:19], s45 offen offset:1024  lds
v_mfma_f32_16x16x32_bf16 v[192:195], v[72:75], v[88:91], v[192:195]
ds_read_b128 v[52:55], v6 offset:1024
v_mfma_f32_16x16x32_bf16 v[224:227], v[44:47], v[88:91], v[224:227]
ds_read_b128 v[76:79], v6 offset:2048
v_mfma_f32_16x16x32_bf16 v[132:135], v[28:31], v[32:35], v[132:135]
ds_read_b128 v[68:71], v6 offset:3072
v_mfma_f32_16x16x32_bf16 v[164:167], v[96:99], v[32:35], v[164:167]
ds_read_b128 v[20:23], v6 offset:4160
v_mfma_f32_16x16x32_bf16 v[196:199], v[72:75], v[32:35], v[196:199]
ds_read_b128 v[36:39], v6 offset:5184
v_mfma_f32_16x16x32_bf16 v[228:231], v[44:47], v[32:35], v[228:231]
v_mfma_f32_16x16x32_bf16 v[136:139], v[28:31], v[80:83], v[136:139]
ds_read_b128 v[40:43], v6 offset:6208
v_mfma_f32_16x16x32_bf16 v[168:171], v[96:99], v[80:83], v[168:171]
buffer_load_dwordx4 v8, s[16:19], s46 offen offset:2048  lds
v_mfma_f32_16x16x32_bf16 v[200:203], v[72:75], v[80:83], v[200:203]
ds_read_b128 v[12:15], v6 offset:7232
v_mfma_f32_16x16x32_bf16 v[232:235], v[44:47], v[80:83], v[232:235]
v_mfma_f32_16x16x32_bf16 v[140:143], v[28:31], v[24:27], v[140:143]
ds_read_b64_tr_b16 v[64:65], v7 offset:0
ds_read_b64_tr_b16 v[66:67], v7 offset:256
v_mfma_f32_16x16x32_bf16 v[172:175], v[96:99], v[24:27], v[172:175]
v_mfma_f32_16x16x32_bf16 v[204:207], v[72:75], v[24:27], v[204:207]
ds_read_b128 v[84:87], v6 offset:8256
v_mfma_f32_16x16x32_bf16 v[236:239], v[44:47], v[24:27], v[236:239]
ds_read_b128 v[60:63], v5 offset:0
v_mfma_f32_16x16x32_bf16 v[240:243], v[92:95], v[28:31], v[240:243]
ds_read_b128 v[88:91], v5 offset:2048
v_mfma_f32_16x16x32_bf16 v[244:247], v[92:95], v[96:99], v[244:247]
buffer_load_dwordx4 v9, s[16:19], s47 offen offset:3072  lds
v_mfma_f32_16x16x32_bf16 v[248:251], v[92:95], v[72:75], v[248:251]
s_waitcnt lgkmcnt(10)
ds_read_b128 v[32:35], v6 offset:9280
v_mfma_f32_16x16x32_bf16 v[252:255], v[92:95], v[44:47], v[252:255]
ds_read_b128 v[80:83], v6 offset:10304
v_mfma_f32_16x16x32_bf16 v[112:115], v[56:59], v[48:51], v[112:115]
ds_read_b128 v[24:27], v6 offset:11328
v_mfma_f32_16x16x32_bf16 v[144:147], v[16:19], v[48:51], v[144:147]
v_mfma_f32_16x16x32_bf16 v[116:119], v[56:59], v[52:55], v[116:119]
ds_read_b128 v[28:31], v6 offset:12416
v_mfma_f32_16x16x32_bf16 v[148:151], v[16:19], v[52:55], v[148:151]
v_mfma_f32_16x16x32_bf16 v[120:123], v[56:59], v[76:79], v[120:123]
ds_read_b128 v[96:99], v6 offset:13440
v_mfma_f32_16x16x32_bf16 v[152:155], v[16:19], v[76:79], v[152:155]
s_add_u32 s37, s37, 1
s_cmp_eq_u32 s37, 9
s_cselect_b32 s37, 0, s37
s_lshl_b32 s51, s37, 7
s_add_u32 s16, s4, s51
s_addc_u32 s17, s5, 0
s_waitcnt lgkmcnt(5)
v_mfma_f32_16x16x32_bf16 v[124:127], v[56:59], v[68:71], v[124:127]
ds_read_b128 v[72:75], v6 offset:14464
v_mfma_f32_16x16x32_bf16 v[156:159], v[16:19], v[68:71], v[156:159]
v_mfma_f32_16x16x32_bf16 v[128:131], v[56:59], v[20:23], v[128:131]
ds_read_b128 v[92:95], v6 offset:15488
v_mfma_f32_16x16x32_bf16 v[160:163], v[16:19], v[20:23], v[160:163]
v_mfma_f32_16x16x32_bf16 v[132:135], v[56:59], v[36:39], v[132:135]
ds_read_b64_tr_b16 v[44:45], v7 offset:1024
ds_read_b64_tr_b16 v[46:47], v7 offset:1280
v_mfma_f32_16x16x32_bf16 v[164:167], v[16:19], v[36:39], v[164:167]
v_mfma_f32_16x16x32_bf16 v[136:139], v[56:59], v[40:43], v[136:139]
s_waitcnt vmcnt(4)
ds_read_b128 v[48:51], v4 offset:8192
v_mfma_f32_16x16x32_bf16 v[168:171], v[16:19], v[40:43], v[168:171]
s_add_u32 m0, s53, 16384
s_nop 0
v_mfma_f32_16x16x32_bf16 v[140:143], v[56:59], v[12:15], v[140:143]
ds_read_b128 v[52:55], v4 offset:10240
v_mfma_f32_16x16x32_bf16 v[172:175], v[16:19], v[12:15], v[172:175]
v_mfma_f32_16x16x32_bf16 v[240:243], v[64:67], v[56:59], v[240:243]
v_mfma_f32_16x16x32_bf16 v[244:247], v[64:67], v[16:19], v[244:247]
v_mfma_f32_16x16x32_bf16 v[112:115], v[60:63], v[84:87], v[112:115]
s_waitcnt lgkmcnt(2)
s_barrier
ds_read_b128 v[76:79], v6 offset:18560
v_mfma_f32_16x16x32_bf16 v[144:147], v[88:91], v[84:87], v[144:147]
ds_read_b128 v[68:71], v6 offset:19584
v_mfma_f32_16x16x32_bf16 v[116:119], v[60:63], v[32:35], v[116:119]
ds_read_b128 v[20:23], v6 offset:20608
v_mfma_f32_16x16x32_bf16 v[148:151], v[88:91], v[32:35], v[148:151]
buffer_load_dwordx4 v8, s[16:19], 0 offen offset:0  lds
v_mfma_f32_16x16x32_bf16 v[120:123], v[60:63], v[80:83], v[120:123]
ds_read_b128 v[36:39], v6 offset:21632
v_mfma_f32_16x16x32_bf16 v[152:155], v[88:91], v[80:83], v[152:155]
ds_read_b128 v[40:43], v6 offset:22720
v_mfma_f32_16x16x32_bf16 v[124:127], v[60:63], v[24:27], v[124:127]
ds_read_b128 v[12:15], v6 offset:23744
v_mfma_f32_16x16x32_bf16 v[156:159], v[88:91], v[24:27], v[156:159]
ds_read_b128 v[56:59], v6 offset:24768
v_mfma_f32_16x16x32_bf16 v[128:131], v[60:63], v[28:31], v[128:131]
ds_read_b128 v[64:67], v6 offset:25792
v_mfma_f32_16x16x32_bf16 v[160:163], v[88:91], v[28:31], v[160:163]
v_mfma_f32_16x16x32_bf16 v[132:135], v[60:63], v[96:99], v[132:135]
ds_read_b64_tr_b16 v[16:17], v7 offset:18560
ds_read_b64_tr_b16 v[18:19], v7 offset:18816
v_mfma_f32_16x16x32_bf16 v[164:167], v[88:91], v[96:99], v[164:167]
buffer_load_dwordx4 v9, s[16:19], s41 offen offset:1024  lds
v_mfma_f32_16x16x32_bf16 v[136:139], v[60:63], v[72:75], v[136:139]
ds_read_b128 v[84:87], v6 offset:26816
v_mfma_f32_16x16x32_bf16 v[168:171], v[88:91], v[72:75], v[168:171]
ds_read_b128 v[32:35], v5 offset:8192
v_mfma_f32_16x16x32_bf16 v[140:143], v[60:63], v[92:95], v[140:143]
ds_read_b128 v[80:83], v5 offset:10240
v_mfma_f32_16x16x32_bf16 v[172:175], v[88:91], v[92:95], v[172:175]
s_waitcnt lgkmcnt(10)
ds_read_b128 v[24:27], v6 offset:27840
v_mfma_f32_16x16x32_bf16 v[240:243], v[44:47], v[60:63], v[240:243]
ds_read_b128 v[28:31], v6 offset:28864
v_mfma_f32_16x16x32_bf16 v[244:247], v[44:47], v[88:91], v[244:247]
v_mfma_f32_16x16x32_bf16 v[112:115], v[48:51], v[76:79], v[112:115]
ds_read_b128 v[96:99], v6 offset:29888
v_mfma_f32_16x16x32_bf16 v[144:147], v[52:55], v[76:79], v[144:147]
buffer_load_dwordx4 v8, s[16:19], s42 offen offset:2048  lds
v_mfma_f32_16x16x32_bf16 v[116:119], v[48:51], v[68:71], v[116:119]
ds_read_b128 v[72:75], v6 offset:30976
v_mfma_f32_16x16x32_bf16 v[148:151], v[52:55], v[68:71], v[148:151]
v_mfma_f32_16x16x32_bf16 v[120:123], v[48:51], v[20:23], v[120:123]
ds_read_b128 v[92:95], v6 offset:32000
v_mfma_f32_16x16x32_bf16 v[152:155], v[52:55], v[20:23], v[152:155]
s_waitcnt lgkmcnt(5)
v_mfma_f32_16x16x32_bf16 v[124:127], v[48:51], v[36:39], v[124:127]
ds_read_b128 v[60:63], v6 offset:33024
v_mfma_f32_16x16x32_bf16 v[156:159], v[52:55], v[36:39], v[156:159]
v_mfma_f32_16x16x32_bf16 v[128:131], v[48:51], v[40:43], v[128:131]
ds_read_b128 v[44:47], v6 offset:34048
v_mfma_f32_16x16x32_bf16 v[160:163], v[52:55], v[40:43], v[160:163]
buffer_load_dwordx4 v9, s[16:19], s43 offen offset:3072  lds
v_mfma_f32_16x16x32_bf16 v[132:135], v[48:51], v[12:15], v[132:135]
ds_read_b64_tr_b16 v[88:89], v7 offset:19584
ds_read_b64_tr_b16 v[90:91], v7 offset:19840
v_mfma_f32_16x16x32_bf16 v[164:167], v[52:55], v[12:15], v[164:167]
v_mfma_f32_16x16x32_bf16 v[136:139], v[48:51], v[56:59], v[136:139]
s_waitcnt vmcnt(0)
ds_read_b128 v[76:79], v4 offset:16384
v_mfma_f32_16x16x32_bf16 v[168:171], v[52:55], v[56:59], v[168:171]
ds_read_b128 v[68:71], v4 offset:18432
v_mfma_f32_16x16x32_bf16 v[140:143], v[48:51], v[64:67], v[140:143]
s_add_u32 m0, s53, 20480
s_nop 0
v_mfma_f32_16x16x32_bf16 v[172:175], v[52:55], v[64:67], v[172:175]
v_mfma_f32_16x16x32_bf16 v[240:243], v[16:19], v[48:51], v[240:243]
v_mfma_f32_16x16x32_bf16 v[244:247], v[16:19], v[52:55], v[244:247]
v_mfma_f32_16x16x32_bf16 v[112:115], v[32:35], v[84:87], v[112:115]
s_waitcnt lgkmcnt(2)
s_barrier
ds_read_b128 v[20:23], v6 offset:37120
v_mfma_f32_16x16x32_bf16 v[144:147], v[80:83], v[84:87], v[144:147]
ds_read_b128 v[36:39], v6 offset:38144
v_mfma_f32_16x16x32_bf16 v[116:119], v[32:35], v[24:27], v[116:119]
ds_read_b128 v[40:43], v6 offset:39168
v_mfma_f32_16x16x32_bf16 v[148:151], v[80:83], v[24:27], v[148:151]
ds_read_b128 v[12:15], v6 offset:40192
v_mfma_f32_16x16x32_bf16 v[120:123], v[32:35], v[28:31], v[120:123]
buffer_load_dwordx4 v8, s[16:19], s44 offen offset:0  lds
v_mfma_f32_16x16x32_bf16 v[152:155], v[80:83], v[28:31], v[152:155]
ds_read_b128 v[56:59], v6 offset:41280
v_mfma_f32_16x16x32_bf16 v[124:127], v[32:35], v[96:99], v[124:127]
ds_read_b128 v[64:67], v6 offset:42304
v_mfma_f32_16x16x32_bf16 v[156:159], v[80:83], v[96:99], v[156:159]
ds_read_b128 v[48:51], v6 offset:43328
v_mfma_f32_16x16x32_bf16 v[128:131], v[32:35], v[72:75], v[128:131]
ds_read_b128 v[16:19], v6 offset:44352
v_mfma_f32_16x16x32_bf16 v[160:163], v[80:83], v[72:75], v[160:163]
v_mfma_f32_16x16x32_bf16 v[132:135], v[32:35], v[92:95], v[132:135]
ds_read_b64_tr_b16 v[52:53], v7 offset:37120
ds_read_b64_tr_b16 v[54:55], v7 offset:37376
v_mfma_f32_16x16x32_bf16 v[164:167], v[80:83], v[92:95], v[164:167]
v_mfma_f32_16x16x32_bf16 v[136:139], v[32:35], v[60:63], v[136:139]
buffer_load_dwordx4 v9, s[16:19], s45 offen offset:1024  lds
v_mfma_f32_16x16x32_bf16 v[168:171], v[80:83], v[60:63], v[168:171]
ds_read_b128 v[84:87], v6 offset:45376
v_mfma_f32_16x16x32_bf16 v[140:143], v[32:35], v[44:47], v[140:143]
ds_read_b128 v[24:27], v5 offset:16384
v_mfma_f32_16x16x32_bf16 v[172:175], v[80:83], v[44:47], v[172:175]
ds_read_b128 v[28:31], v5 offset:18432
v_mfma_f32_16x16x32_bf16 v[240:243], v[88:91], v[32:35], v[240:243]
s_waitcnt lgkmcnt(10)
ds_read_b128 v[96:99], v6 offset:46400
v_mfma_f32_16x16x32_bf16 v[244:247], v[88:91], v[80:83], v[244:247]
ds_read_b128 v[72:75], v6 offset:47424
v_mfma_f32_16x16x32_bf16 v[112:115], v[76:79], v[20:23], v[112:115]
ds_read_b128 v[92:95], v6 offset:48448
v_mfma_f32_16x16x32_bf16 v[144:147], v[68:71], v[20:23], v[144:147]
v_mfma_f32_16x16x32_bf16 v[116:119], v[76:79], v[36:39], v[116:119]
buffer_load_dwordx4 v8, s[16:19], s46 offen offset:2048  lds
v_mfma_f32_16x16x32_bf16 v[148:151], v[68:71], v[36:39], v[148:151]
ds_read_b128 v[60:63], v6 offset:49536
v_mfma_f32_16x16x32_bf16 v[120:123], v[76:79], v[40:43], v[120:123]
ds_read_b128 v[44:47], v6 offset:50560
v_mfma_f32_16x16x32_bf16 v[152:155], v[68:71], v[40:43], v[152:155]
s_waitcnt lgkmcnt(6)
v_mfma_f32_16x16x32_bf16 v[124:127], v[76:79], v[12:15], v[124:127]
ds_read_b128 v[32:35], v6 offset:51584
v_mfma_f32_16x16x32_bf16 v[156:159], v[68:71], v[12:15], v[156:159]
v_mfma_f32_16x16x32_bf16 v[128:131], v[76:79], v[56:59], v[128:131]
ds_read_b128 v[88:91], v6 offset:52608
v_mfma_f32_16x16x32_bf16 v[160:163], v[68:71], v[56:59], v[160:163]
v_mfma_f32_16x16x32_bf16 v[132:135], v[76:79], v[64:67], v[132:135]
buffer_load_dwordx4 v9, s[16:19], s47 offen offset:3072  lds
v_mfma_f32_16x16x32_bf16 v[164:167], v[68:71], v[64:67], v[164:167]
ds_read_b64_tr_b16 v[80:81], v7 offset:38144
ds_read_b64_tr_b16 v[82:83], v7 offset:38400
v_mfma_f32_16x16x32_bf16 v[136:139], v[76:79], v[48:51], v[136:139]
ds_read_b128 v[20:23], v6 offset:0
v_mfma_f32_16x16x32_bf16 v[168:171], v[68:71], v[48:51], v[168:171]
ds_read_b128 v[36:39], v4 offset:4096
v_mfma_f32_16x16x32_bf16 v[140:143], v[76:79], v[16:19], v[140:143]
ds_read_b128 v[40:43], v4 offset:6144
v_mfma_f32_16x16x32_bf16 v[172:175], v[68:71], v[16:19], v[172:175]
ds_read_b128 v[12:15], v6 offset:1024
v_mfma_f32_16x16x32_bf16 v[240:243], v[52:55], v[76:79], v[240:243]
ds_read_b128 v[56:59], v6 offset:2048
v_mfma_f32_16x16x32_bf16 v[244:247], v[52:55], v[68:71], v[244:247]
v_mfma_f32_16x16x32_bf16 v[112:115], v[24:27], v[84:87], v[112:115]
s_add_u32 s37, s37, 1
s_cmp_eq_u32 s37, 9
s_cselect_b32 s37, 0, s37
s_lshl_b32 s51, s37, 7
s_add_u32 s16, s4, s51
s_addc_u32 s17, s5, 0
s_waitcnt lgkmcnt(7)
v_mfma_f32_16x16x32_bf16 v[144:147], v[28:31], v[84:87], v[144:147]
ds_read_b128 v[64:67], v6 offset:3072
v_mfma_f32_16x16x32_bf16 v[116:119], v[24:27], v[96:99], v[116:119]
ds_read_b128 v[48:51], v6 offset:4160
v_mfma_f32_16x16x32_bf16 v[148:151], v[28:31], v[96:99], v[148:151]
v_mfma_f32_16x16x32_bf16 v[120:123], v[24:27], v[72:75], v[120:123]
ds_read_b128 v[16:19], v6 offset:5184
v_mfma_f32_16x16x32_bf16 v[152:155], v[28:31], v[72:75], v[152:155]
v_mfma_f32_16x16x32_bf16 v[124:127], v[24:27], v[92:95], v[124:127]
ds_read_b128 v[76:79], v6 offset:6208
v_mfma_f32_16x16x32_bf16 v[156:159], v[28:31], v[92:95], v[156:159]
v_mfma_f32_16x16x32_bf16 v[128:131], v[24:27], v[60:63], v[128:131]
ds_read_b128 v[52:55], v6 offset:7232
v_mfma_f32_16x16x32_bf16 v[160:163], v[28:31], v[60:63], v[160:163]
v_mfma_f32_16x16x32_bf16 v[132:135], v[24:27], v[44:47], v[132:135]
ds_read_b64_tr_b16 v[68:69], v7 offset:0
ds_read_b64_tr_b16 v[70:71], v7 offset:256
v_mfma_f32_16x16x32_bf16 v[164:167], v[28:31], v[44:47], v[164:167]
v_mfma_f32_16x16x32_bf16 v[136:139], v[24:27], v[32:35], v[136:139]
ds_read_b128 v[84:87], v6 offset:8256
v_mfma_f32_16x16x32_bf16 v[168:171], v[28:31], v[32:35], v[168:171]
s_waitcnt lgkmcnt(10)
ds_read_b128 v[96:99], v5 offset:4096
v_mfma_f32_16x16x32_bf16 v[140:143], v[24:27], v[88:91], v[140:143]
ds_read_b128 v[72:75], v5 offset:6144
v_mfma_f32_16x16x32_bf16 v[172:175], v[28:31], v[88:91], v[172:175]
ds_read_b128 v[92:95], v6 offset:9280
v_mfma_f32_16x16x32_bf16 v[240:243], v[80:83], v[24:27], v[240:243]
ds_read_b128 v[60:63], v6 offset:10304
v_mfma_f32_16x16x32_bf16 v[244:247], v[80:83], v[28:31], v[244:247]
v_mfma_f32_16x16x32_bf16 v[176:179], v[36:39], v[20:23], v[176:179]
ds_read_b128 v[44:47], v6 offset:11328
v_mfma_f32_16x16x32_bf16 v[208:211], v[40:43], v[20:23], v[208:211]
s_waitcnt lgkmcnt(6)
v_mfma_f32_16x16x32_bf16 v[180:183], v[36:39], v[12:15], v[180:183]
ds_read_b128 v[32:35], v6 offset:12416
v_mfma_f32_16x16x32_bf16 v[212:215], v[40:43], v[12:15], v[212:215]
v_cvt_pk_bf16_f32 v100, v112, v116
v_cvt_pk_bf16_f32 v101, v120, v124
v_cvt_pk_bf16_f32 v102, v128, v132
v_cvt_pk_bf16_f32 v103, v136, v140
s_mov_b32 s52, 0
buffer_store_dwordx4 v[100:103], v10, s[32:35], s52 offen sc1
v_mfma_f32_16x16x32_bf16 v[184:187], v[36:39], v[56:59], v[184:187]
ds_read_b128 v[88:91], v6 offset:13440
v_mfma_f32_16x16x32_bf16 v[216:219], v[40:43], v[56:59], v[216:219]
v_mfma_f32_16x16x32_bf16 v[188:191], v[36:39], v[64:67], v[188:191]
ds_read_b128 v[24:27], v6 offset:14464
v_mfma_f32_16x16x32_bf16 v[220:223], v[40:43], v[64:67], v[220:223]
v_mfma_f32_16x16x32_bf16 v[192:195], v[36:39], v[48:51], v[192:195]
ds_read_b128 v[80:83], v6 offset:15488
v_mfma_f32_16x16x32_bf16 v[224:227], v[40:43], v[48:51], v[224:227]
v_cvt_pk_bf16_f32 v104, v113, v117
v_cvt_pk_bf16_f32 v105, v121, v125
v_cvt_pk_bf16_f32 v106, v129, v133
v_cvt_pk_bf16_f32 v107, v137, v141
s_mov_b32 s52, 9216
buffer_store_dwordx4 v[104:107], v10, s[32:35], s52 offen sc1
v_mfma_f32_16x16x32_bf16 v[196:199], v[36:39], v[16:19], v[196:199]
ds_read_b64_tr_b16 v[28:29], v7 offset:1024
ds_read_b64_tr_b16 v[30:31], v7 offset:1280
v_mfma_f32_16x16x32_bf16 v[228:231], v[40:43], v[16:19], v[228:231]
v_mfma_f32_16x16x32_bf16 v[200:203], v[36:39], v[76:79], v[200:203]
ds_read_b128 v[20:23], v6 offset:18560
v_mfma_f32_16x16x32_bf16 v[232:235], v[40:43], v[76:79], v[232:235]
ds_read_b128 v[12:15], v4 offset:12288
v_mfma_f32_16x16x32_bf16 v[204:207], v[36:39], v[52:55], v[204:207]
ds_read_b128 v[56:59], v4 offset:14336
v_mfma_f32_16x16x32_bf16 v[236:239], v[40:43], v[52:55], v[236:239]
v_cvt_pk_bf16_f32 v108, v114, v118
v_cvt_pk_bf16_f32 v109, v122, v126
v_cvt_pk_bf16_f32 v110, v130, v134
v_cvt_pk_bf16_f32 v111, v138, v142
s_mov_b32 s52, 18432
buffer_store_dwordx4 v[108:111], v10, s[32:35], s52 offen sc1
v_mfma_f32_16x16x32_bf16 v[248:251], v[68:71], v[36:39], v[248:251]
s_waitcnt lgkmcnt(10)
ds_read_b128 v[64:67], v6 offset:19584
v_mfma_f32_16x16x32_bf16 v[252:255], v[68:71], v[40:43], v[252:255]
ds_read_b128 v[48:51], v6 offset:20608
v_mfma_f32_16x16x32_bf16 v[176:179], v[96:99], v[84:87], v[176:179]
ds_read_b128 v[16:19], v6 offset:21632
v_mfma_f32_16x16x32_bf16 v[208:211], v[72:75], v[84:87], v[208:211]
v_mfma_f32_16x16x32_bf16 v[180:183], v[96:99], v[92:95], v[180:183]
ds_read_b128 v[76:79], v6 offset:22720
v_mfma_f32_16x16x32_bf16 v[212:215], v[72:75], v[92:95], v[212:215]
v_cvt_pk_bf16_f32 v100, v115, v119
v_cvt_pk_bf16_f32 v101, v123, v127
v_cvt_pk_bf16_f32 v102, v131, v135
v_cvt_pk_bf16_f32 v103, v139, v143
s_mov_b32 s52, 27648
buffer_store_dwordx4 v[100:103], v10, s[32:35], s52 offen sc1
v_mfma_f32_16x16x32_bf16 v[184:187], v[96:99], v[60:63], v[184:187]
ds_read_b128 v[52:55], v6 offset:23744
v_mfma_f32_16x16x32_bf16 v[216:219], v[72:75], v[60:63], v[216:219]
s_waitcnt lgkmcnt(5)
v_mfma_f32_16x16x32_bf16 v[188:191], v[96:99], v[44:47], v[188:191]
ds_read_b128 v[36:39], v6 offset:24768
v_mfma_f32_16x16x32_bf16 v[220:223], v[72:75], v[44:47], v[220:223]
v_mfma_f32_16x16x32_bf16 v[192:195], v[96:99], v[32:35], v[192:195]
ds_read_b128 v[68:71], v6 offset:25792
v_mfma_f32_16x16x32_bf16 v[224:227], v[72:75], v[32:35], v[224:227]
v_cvt_pk_bf16_f32 v104, v144, v148
v_cvt_pk_bf16_f32 v105, v152, v156
v_cvt_pk_bf16_f32 v106, v160, v164
v_cvt_pk_bf16_f32 v107, v168, v172
s_mov_b32 s52, 147456
buffer_store_dwordx4 v[104:107], v10, s[32:35], s52 offen sc1
v_mfma_f32_16x16x32_bf16 v[196:199], v[96:99], v[88:91], v[196:199]
ds_read_b64_tr_b16 v[40:41], v7 offset:18560
ds_read_b64_tr_b16 v[42:43], v7 offset:18816
v_mfma_f32_16x16x32_bf16 v[228:231], v[72:75], v[88:91], v[228:231]
v_mfma_f32_16x16x32_bf16 v[200:203], v[96:99], v[24:27], v[200:203]
ds_read_b128 v[84:87], v6 offset:26816
v_mfma_f32_16x16x32_bf16 v[232:235], v[72:75], v[24:27], v[232:235]
ds_read_b128 v[92:95], v5 offset:12288
v_mfma_f32_16x16x32_bf16 v[204:207], v[96:99], v[80:83], v[204:207]
ds_read_b128 v[60:63], v5 offset:14336
v_mfma_f32_16x16x32_bf16 v[236:239], v[72:75], v[80:83], v[236:239]
v_cvt_pk_bf16_f32 v108, v145, v149
v_cvt_pk_bf16_f32 v109, v153, v157
v_cvt_pk_bf16_f32 v110, v161, v165
v_cvt_pk_bf16_f32 v111, v169, v173
s_mov_b32 s52, 156672
buffer_store_dwordx4 v[108:111], v10, s[32:35], s52 offen sc1
v_mfma_f32_16x16x32_bf16 v[248:251], v[28:31], v[96:99], v[248:251]
ds_read_b128 v[44:47], v6 offset:27840
v_mfma_f32_16x16x32_bf16 v[252:255], v[28:31], v[72:75], v[252:255]
ds_read_b128 v[32:35], v6 offset:28864
v_mfma_f32_16x16x32_bf16 v[176:179], v[12:15], v[20:23], v[176:179]
ds_read_b128 v[88:91], v6 offset:29888
v_mfma_f32_16x16x32_bf16 v[208:211], v[56:59], v[20:23], v[208:211]
s_waitcnt lgkmcnt(6)
v_mfma_f32_16x16x32_bf16 v[180:183], v[12:15], v[64:67], v[180:183]
ds_read_b128 v[24:27], v6 offset:30976
v_mfma_f32_16x16x32_bf16 v[212:215], v[56:59], v[64:67], v[212:215]
v_cvt_pk_bf16_f32 v100, v146, v150
v_cvt_pk_bf16_f32 v101, v154, v158
v_cvt_pk_bf16_f32 v102, v162, v166
v_cvt_pk_bf16_f32 v103, v170, v174
s_mov_b32 s52, 165888
buffer_store_dwordx4 v[100:103], v10, s[32:35], s52 offen sc1
v_mfma_f32_16x16x32_bf16 v[184:187], v[12:15], v[48:51], v[184:187]
ds_read_b128 v[80:83], v6 offset:32000
v_mfma_f32_16x16x32_bf16 v[216:219], v[56:59], v[48:51], v[216:219]
v_mfma_f32_16x16x32_bf16 v[188:191], v[12:15], v[16:19], v[188:191]
ds_read_b128 v[96:99], v6 offset:33024
v_mfma_f32_16x16x32_bf16 v[220:223], v[56:59], v[16:19], v[220:223]
v_mfma_f32_16x16x32_bf16 v[192:195], v[12:15], v[76:79], v[192:195]
ds_read_b128 v[28:31], v6 offset:34048
v_mfma_f32_16x16x32_bf16 v[224:227], v[56:59], v[76:79], v[224:227]
v_cvt_pk_bf16_f32 v104, v147, v151
v_cvt_pk_bf16_f32 v105, v155, v159
v_cvt_pk_bf16_f32 v106, v163, v167
v_cvt_pk_bf16_f32 v107, v171, v175
s_mov_b32 s52, 175104
buffer_store_dwordx4 v[104:107], v10, s[32:35], s52 offen sc1
v_mfma_f32_16x16x32_bf16 v[196:199], v[12:15], v[52:55], v[196:199]
ds_read_b64_tr_b16 v[72:73], v7 offset:19584
ds_read_b64_tr_b16 v[74:75], v7 offset:19840
v_mfma_f32_16x16x32_bf16 v[228:231], v[56:59], v[52:55], v[228:231]
v_mfma_f32_16x16x32_bf16 v[200:203], v[12:15], v[36:39], v[200:203]
ds_read_b128 v[20:23], v6 offset:37120
v_mfma_f32_16x16x32_bf16 v[232:235], v[56:59], v[36:39], v[232:235]
s_waitcnt vmcnt(8)
ds_read_b128 v[64:67], v4 offset:20480
v_mfma_f32_16x16x32_bf16 v[204:207], v[12:15], v[68:71], v[204:207]
ds_read_b128 v[48:51], v4 offset:22528
v_mfma_f32_16x16x32_bf16 v[236:239], v[56:59], v[68:71], v[236:239]
v_cvt_pk_bf16_f32 v240, v240, v241
v_cvt_pk_bf16_f32 v241, v242, v243
s_mov_b32 s52, 0
buffer_store_dwordx2 v[240:241], v11, s[32:35], s52 offen
v_mfma_f32_16x16x32_bf16 v[248:251], v[40:43], v[12:15], v[248:251]
s_waitcnt lgkmcnt(10)
ds_read_b128 v[16:19], v6 offset:38144
v_mfma_f32_16x16x32_bf16 v[252:255], v[40:43], v[56:59], v[252:255]
ds_read_b128 v[76:79], v6 offset:39168
v_mfma_f32_16x16x32_bf16 v[176:179], v[92:95], v[84:87], v[176:179]
ds_read_b128 v[52:55], v6 offset:40192
v_mfma_f32_16x16x32_bf16 v[208:211], v[60:63], v[84:87], v[208:211]
v_mfma_f32_16x16x32_bf16 v[180:183], v[92:95], v[44:47], v[180:183]
ds_read_b128 v[36:39], v6 offset:41280
v_mfma_f32_16x16x32_bf16 v[212:215], v[60:63], v[44:47], v[212:215]
v_cvt_pk_bf16_f32 v244, v244, v245
v_cvt_pk_bf16_f32 v245, v246, v247
s_mov_b32 s52, 147456
buffer_store_dwordx2 v[244:245], v11, s[32:35], s52 offen
v_mfma_f32_16x16x32_bf16 v[184:187], v[92:95], v[32:35], v[184:187]
ds_read_b128 v[68:71], v6 offset:42304
v_mfma_f32_16x16x32_bf16 v[216:219], v[60:63], v[32:35], v[216:219]
s_waitcnt lgkmcnt(5)
v_mfma_f32_16x16x32_bf16 v[188:191], v[92:95], v[88:91], v[188:191]
ds_read_b128 v[12:15], v6 offset:43328
v_mfma_f32_16x16x32_bf16 v[220:223], v[60:63], v[88:91], v[220:223]
v_mfma_f32_16x16x32_bf16 v[192:195], v[92:95], v[24:27], v[192:195]
ds_read_b128 v[40:43], v6 offset:44352
v_mfma_f32_16x16x32_bf16 v[224:227], v[60:63], v[24:27], v[224:227]
v_mfma_f32_16x16x32_bf16 v[196:199], v[92:95], v[80:83], v[196:199]
ds_read_b64_tr_b16 v[56:57], v7 offset:37120
ds_read_b64_tr_b16 v[58:59], v7 offset:37376
v_mfma_f32_16x16x32_bf16 v[228:231], v[60:63], v[80:83], v[228:231]
v_mfma_f32_16x16x32_bf16 v[200:203], v[92:95], v[96:99], v[200:203]
ds_read_b128 v[84:87], v6 offset:45376
v_mfma_f32_16x16x32_bf16 v[232:235], v[60:63], v[96:99], v[232:235]
ds_read_b128 v[44:47], v5 offset:20480
v_mfma_f32_16x16x32_bf16 v[204:207], v[92:95], v[28:31], v[204:207]
ds_read_b128 v[32:35], v5 offset:22528
v_mfma_f32_16x16x32_bf16 v[236:239], v[60:63], v[28:31], v[236:239]
ds_read_b128 v[88:91], v6 offset:46400
v_mfma_f32_16x16x32_bf16 v[248:251], v[72:75], v[92:95], v[248:251]
ds_read_b128 v[24:27], v6 offset:47424
v_mfma_f32_16x16x32_bf16 v[252:255], v[72:75], v[60:63], v[252:255]
v_mfma_f32_16x16x32_bf16 v[176:179], v[64:67], v[20:23], v[176:179]
ds_read_b128 v[80:83], v6 offset:48448
v_mfma_f32_16x16x32_bf16 v[208:211], v[48:51], v[20:23], v[208:211]
s_waitcnt lgkmcnt(6)
v_mfma_f32_16x16x32_bf16 v[180:183], v[64:67], v[16:19], v[180:183]
ds_read_b128 v[96:99], v6 offset:49536
v_mfma_f32_16x16x32_bf16 v[212:215], v[48:51], v[16:19], v[212:215]
v_mfma_f32_16x16x32_bf16 v[184:187], v[64:67], v[76:79], v[184:187]
ds_read_b128 v[28:31], v6 offset:50560
v_mfma_f32_16x16x32_bf16 v[216:219], v[48:51], v[76:79], v[216:219]
v_mfma_f32_16x16x32_bf16 v[188:191], v[64:67], v[52:55], v[188:191]
ds_read_b128 v[92:95], v6 offset:51584
v_mfma_f32_16x16x32_bf16 v[220:223], v[48:51], v[52:55], v[220:223]
v_mfma_f32_16x16x32_bf16 v[192:195], v[64:67], v[36:39], v[192:195]
ds_read_b128 v[72:75], v6 offset:52608
v_mfma_f32_16x16x32_bf16 v[224:227], v[48:51], v[36:39], v[224:227]
v_mfma_f32_16x16x32_bf16 v[196:199], v[64:67], v[68:71], v[196:199]
ds_read_b64_tr_b16 v[60:61], v7 offset:38144
ds_read_b64_tr_b16 v[62:63], v7 offset:38400
v_mfma_f32_16x16x32_bf16 v[228:231], v[48:51], v[68:71], v[228:231]
v_mfma_f32_16x16x32_bf16 v[200:203], v[64:67], v[12:15], v[200:203]
v_mfma_f32_16x16x32_bf16 v[232:235], v[48:51], v[12:15], v[232:235]
v_mfma_f32_16x16x32_bf16 v[204:207], v[64:67], v[40:43], v[204:207]
v_mfma_f32_16x16x32_bf16 v[236:239], v[48:51], v[40:43], v[236:239]
v_mfma_f32_16x16x32_bf16 v[248:251], v[56:59], v[64:67], v[248:251]
v_mfma_f32_16x16x32_bf16 v[252:255], v[56:59], v[48:51], v[252:255]
s_waitcnt lgkmcnt(2)
v_mfma_f32_16x16x32_bf16 v[176:179], v[44:47], v[84:87], v[176:179]
v_mfma_f32_16x16x32_bf16 v[208:211], v[32:35], v[84:87], v[208:211]
v_mfma_f32_16x16x32_bf16 v[180:183], v[44:47], v[88:91], v[180:183]
v_mfma_f32_16x16x32_bf16 v[212:215], v[32:35], v[88:91], v[212:215]
v_mfma_f32_16x16x32_bf16 v[184:187], v[44:47], v[24:27], v[184:187]
v_mfma_f32_16x16x32_bf16 v[216:219], v[32:35], v[24:27], v[216:219]
v_mfma_f32_16x16x32_bf16 v[188:191], v[44:47], v[80:83], v[188:191]
v_mfma_f32_16x16x32_bf16 v[220:223], v[32:35], v[80:83], v[220:223]
v_mfma_f32_16x16x32_bf16 v[192:195], v[44:47], v[96:99], v[192:195]
v_mfma_f32_16x16x32_bf16 v[224:227], v[32:35], v[96:99], v[224:227]
v_mfma_f32_16x16x32_bf16 v[196:199], v[44:47], v[28:31], v[196:199]
v_mfma_f32_16x16x32_bf16 v[228:231], v[32:35], v[28:31], v[228:231]
v_mfma_f32_16x16x32_bf16 v[200:203], v[44:47], v[92:95], v[200:203]
v_mfma_f32_16x16x32_bf16 v[232:235], v[32:35], v[92:95], v[232:235]
v_mfma_f32_16x16x32_bf16 v[204:207], v[44:47], v[72:75], v[204:207]
v_mfma_f32_16x16x32_bf16 v[236:239], v[32:35], v[72:75], v[236:239]
s_waitcnt lgkmcnt(0)
v_mfma_f32_16x16x32_bf16 v[248:251], v[60:63], v[44:47], v[248:251]
v_mfma_f32_16x16x32_bf16 v[252:255], v[60:63], v[32:35], v[252:255]
s_nop 1
s_nop 1
v_cvt_pk_bf16_f32 v100, v176, v180
v_cvt_pk_bf16_f32 v101, v184, v188
v_cvt_pk_bf16_f32 v102, v192, v196
v_cvt_pk_bf16_f32 v103, v200, v204
s_mov_b32 s52, 294912
buffer_store_dwordx4 v[100:103], v10, s[32:35], s52 offen sc1
v_cvt_pk_bf16_f32 v104, v177, v181
v_cvt_pk_bf16_f32 v105, v185, v189
v_cvt_pk_bf16_f32 v106, v193, v197
v_cvt_pk_bf16_f32 v107, v201, v205
s_mov_b32 s52, 304128
buffer_store_dwordx4 v[104:107], v10, s[32:35], s52 offen sc1
v_cvt_pk_bf16_f32 v108, v178, v182
v_cvt_pk_bf16_f32 v109, v186, v190
v_cvt_pk_bf16_f32 v110, v194, v198
v_cvt_pk_bf16_f32 v111, v202, v206
s_mov_b32 s52, 313344
buffer_store_dwordx4 v[108:111], v10, s[32:35], s52 offen sc1
v_cvt_pk_bf16_f32 v20, v179, v183
v_cvt_pk_bf16_f32 v21, v187, v191
v_cvt_pk_bf16_f32 v22, v195, v199
v_cvt_pk_bf16_f32 v23, v203, v207
s_mov_b32 s52, 322560
buffer_store_dwordx4 v[20:23], v10, s[32:35], s52 offen sc1
v_cvt_pk_bf16_f32 v16, v208, v212
v_cvt_pk_bf16_f32 v17, v216, v220
v_cvt_pk_bf16_f32 v18, v224, v228
v_cvt_pk_bf16_f32 v19, v232, v236
s_mov_b32 s52, 442368
buffer_store_dwordx4 v[16:19], v10, s[32:35], s52 offen sc1
v_cvt_pk_bf16_f32 v76, v209, v213
v_cvt_pk_bf16_f32 v77, v217, v221
v_cvt_pk_bf16_f32 v78, v225, v229
v_cvt_pk_bf16_f32 v79, v233, v237
s_mov_b32 s52, 451584
buffer_store_dwordx4 v[76:79], v10, s[32:35], s52 offen sc1
v_cvt_pk_bf16_f32 v52, v210, v214
v_cvt_pk_bf16_f32 v53, v218, v222
v_cvt_pk_bf16_f32 v54, v226, v230
v_cvt_pk_bf16_f32 v55, v234, v238
s_mov_b32 s52, 460800
buffer_store_dwordx4 v[52:55], v10, s[32:35], s52 offen sc1
v_cvt_pk_bf16_f32 v36, v211, v215
v_cvt_pk_bf16_f32 v37, v219, v223
v_cvt_pk_bf16_f32 v38, v227, v231
v_cvt_pk_bf16_f32 v39, v235, v239
s_mov_b32 s52, 470016
buffer_store_dwordx4 v[36:39], v10, s[32:35], s52 offen sc1
v_cvt_pk_bf16_f32 v248, v248, v249
v_cvt_pk_bf16_f32 v249, v250, v251
s_mov_b32 s52, 294912
buffer_store_dwordx2 v[248:249], v11, s[32:35], s52 offen
v_cvt_pk_bf16_f32 v252, v252, v253
v_cvt_pk_bf16_f32 v253, v254, v255
s_mov_b32 s52, 442368
buffer_store_dwordx2 v[252:253], v11, s[32:35], s52 offen
s_endpgm
.p2align 6
L_producer:
s_mov_b32 s40, 0
s_mov_b32 s41, 18432
s_mov_b32 s42, 36864
s_mov_b32 s43, 55296
s_mov_b32 s44, 73728
s_mov_b32 s45, 92160
s_mov_b32 s46, 110592
s_mov_b32 s47, 129024
v_lshrrev_b32 v6, 5, v19
v_and_b32 v7, 31, v19
s_lshl_b32 s52, s39, 4
v_lshl_add_u32 v8, v6, 3, s52
v_mul_u32_u24 v8, 18432, v8
v_lshl_add_u32 v8, v7, 4, v8
s_lshl_b32 s50, s55, 2
v_add_u32 v0, s50, v8
v_lshrrev_b32 v8, 2, v19
v_add_u32 v8, s52, v8
v_mul_u32_u24 v8, 18432, v8
v_and_b32 v9, 3, v19
v_lshl_add_u32 v8, v9, 4, v8
s_lshl_b32 s50, s54, 2
v_add_u32 v1, s50, v8
s_mov_b32 s22, 1179648
s_mov_b32 s23, 0x20000
s_waitcnt lgkmcnt(0)
s_mul_i32 s51, s37, 1179648
s_add_u32 s20, s6, s51
s_addc_u32 s21, s7, 0
buffer_load_dwordx4 v[72:75], v0, s[20:23], s40 offen
buffer_load_dwordx4 v[76:79], v0, s[20:23], s41 offen
buffer_load_dwordx4 v[80:83], v0, s[20:23], s42 offen
buffer_load_dwordx4 v[84:87], v0, s[20:23], s43 offen
buffer_load_dwordx4 v[88:91], v0, s[20:23], s44 offen
buffer_load_dwordx4 v[92:95], v0, s[20:23], s45 offen
buffer_load_dwordx4 v[96:99], v0, s[20:23], s46 offen
buffer_load_dwordx4 v[100:103], v0, s[20:23], s47 offen
buffer_load_dwordx4 v[104:107], v1, s[20:23], 0 offen
s_add_u32 s37, s37, 1
s_cmp_eq_u32 s37, 9
s_cselect_b32 s37, 0, s37
s_mul_i32 s51, s37, 1179648
s_add_u32 s20, s6, s51
s_addc_u32 s21, s7, 0
buffer_load_dwordx4 v[108:111], v0, s[20:23], s40 offen
buffer_load_dwordx4 v[112:115], v0, s[20:23], s41 offen
buffer_load_dwordx4 v[116:119], v0, s[20:23], s42 offen
buffer_load_dwordx4 v[120:123], v0, s[20:23], s43 offen
buffer_load_dwordx4 v[124:127], v0, s[20:23], s44 offen
buffer_load_dwordx4 v[128:131], v0, s[20:23], s45 offen
buffer_load_dwordx4 v[132:135], v0, s[20:23], s46 offen
buffer_load_dwordx4 v[136:139], v0, s[20:23], s47 offen
buffer_load_dwordx4 v[140:143], v1, s[20:23], 0 offen
s_add_u32 s37, s37, 1
s_cmp_eq_u32 s37, 9
s_cselect_b32 s37, 0, s37
s_mul_i32 s51, s37, 1179648
s_add_u32 s20, s6, s51
s_addc_u32 s21, s7, 0
s_lshr_b32 s52, s39, 1
s_mul_i32 s52, s52, 8256
s_and_b32 s53, s39, 1
s_lshl_b32 s53, s53, 9
s_add_u32 s52, s52, s53
s_add_u32 s52, s52, 98304
v_lshl_add_u32 v4, v6, 8, s52
v_and_b32 v8, 1, v7
v_mul_u32_u24 v8, 4160, v8
v_add_u32 v4, v4, v8
v_lshrrev_b32 v8, 1, v7
v_lshl_add_u32 v4, v8, 4, v4
v_bfe_u32 v8, v19, 4, 1
v_and_b32 v10, 15, v19
s_lshl_b32 s52, s39, 9
s_add_u32 s52, s52, 114816
v_lshl_add_u32 v5, v6, 7, s52
v_lshl_add_u32 v5, v8, 8, v5
v_lshl_add_u32 v5, v10, 3, v5
s_lshr_b32 s8, s39, 1
s_mul_i32 s52, s8, 576
s_add_u32 s52, s52, 135424
v_lshl_add_u32 v2, v7, 4, s52
s_add_u32 s52, s52, 512
v_lshl_add_u32 v3, v9, 4, s52
s_barrier
ds_read_b128 v[40:43], v2 offset:0
ds_read_b128 v[44:47], v2 offset:10368
ds_read_b128 v[48:51], v3 offset:0
ds_read_b128 v[52:55], v3 offset:10368
s_waitcnt lgkmcnt(0)
s_waitcnt vmcnt(9)
v_cvt_f32_i32 v72, v72
v_cvt_f32_i32 v76, v76
v_cvt_f32_i32 v80, v80
v_cvt_f32_i32 v84, v84
v_cvt_f32_i32 v88, v88
v_cvt_f32_i32 v92, v92
v_cvt_f32_i32 v96, v96
v_cvt_f32_i32 v100, v100
v_fma_f32 v72, v72, v40, -v44
v_fma_f32 v76, v76, v40, -v44
v_fma_f32 v80, v80, v40, -v44
v_fma_f32 v84, v84, v40, -v44
v_fma_f32 v88, v88, v40, -v44
v_fma_f32 v92, v92, v40, -v44
v_fma_f32 v96, v96, v40, -v44
v_fma_f32 v100, v100, v40, -v44
v_cvt_pk_bf16_f32 v20, v72, v76
v_cvt_pk_bf16_f32 v21, v80, v84
v_cvt_pk_bf16_f32 v22, v88, v92
v_cvt_pk_bf16_f32 v23, v96, v100
ds_write_b128 v4, v[20:23] offset:0
ds_read_b128 v[56:59], v2 offset:1152
ds_read_b128 v[60:63], v2 offset:11520
ds_read_b128 v[64:67], v3 offset:1152
ds_read_b128 v[68:71], v3 offset:11520
v_cvt_f32_i32 v73, v73
v_cvt_f32_i32 v77, v77
v_cvt_f32_i32 v81, v81
v_cvt_f32_i32 v85, v85
v_cvt_f32_i32 v89, v89
v_cvt_f32_i32 v93, v93
v_cvt_f32_i32 v97, v97
v_cvt_f32_i32 v101, v101
v_fma_f32 v73, v73, v41, -v45
v_fma_f32 v77, v77, v41, -v45
v_fma_f32 v81, v81, v41, -v45
v_fma_f32 v85, v85, v41, -v45
v_fma_f32 v89, v89, v41, -v45
v_fma_f32 v93, v93, v41, -v45
v_fma_f32 v97, v97, v41, -v45
v_fma_f32 v101, v101, v41, -v45
v_cvt_pk_bf16_f32 v24, v73, v77
v_cvt_pk_bf16_f32 v25, v81, v85
v_cvt_pk_bf16_f32 v26, v89, v93
v_cvt_pk_bf16_f32 v27, v97, v101
ds_write_b128 v4, v[24:27] offset:1024
v_cvt_f32_i32 v104, v104
v_cvt_f32_i32 v105, v105
v_cvt_f32_i32 v106, v106
v_cvt_f32_i32 v107, v107
v_fma_f32 v104, v104, v48, -v52
v_fma_f32 v105, v105, v49, -v53
v_fma_f32 v106, v106, v50, -v54
v_fma_f32 v107, v107, v51, -v55
v_cvt_pk_bf16_f32 v36, v104, v105
v_cvt_pk_bf16_f32 v37, v106, v107
ds_write_b64 v5, v[36:37] offset:0
v_cvt_f32_i32 v74, v74
v_cvt_f32_i32 v78, v78
v_cvt_f32_i32 v82, v82
v_cvt_f32_i32 v86, v86
v_cvt_f32_i32 v90, v90
v_cvt_f32_i32 v94, v94
v_cvt_f32_i32 v98, v98
v_cvt_f32_i32 v102, v102
v_fma_f32 v74, v74, v42, -v46
v_fma_f32 v78, v78, v42, -v46
v_fma_f32 v82, v82, v42, -v46
v_fma_f32 v86, v86, v42, -v46
v_fma_f32 v90, v90, v42, -v46
v_fma_f32 v94, v94, v42, -v46
v_fma_f32 v98, v98, v42, -v46
v_fma_f32 v102, v102, v42, -v46
v_cvt_pk_bf16_f32 v28, v74, v78
v_cvt_pk_bf16_f32 v29, v82, v86
v_cvt_pk_bf16_f32 v30, v90, v94
v_cvt_pk_bf16_f32 v31, v98, v102
ds_write_b128 v4, v[28:31] offset:2048
v_cvt_f32_i32 v75, v75
v_cvt_f32_i32 v79, v79
v_cvt_f32_i32 v83, v83
v_cvt_f32_i32 v87, v87
v_cvt_f32_i32 v91, v91
v_cvt_f32_i32 v95, v95
v_cvt_f32_i32 v99, v99
v_cvt_f32_i32 v103, v103
v_fma_f32 v75, v75, v43, -v47
v_fma_f32 v79, v79, v43, -v47
v_fma_f32 v83, v83, v43, -v47
v_fma_f32 v87, v87, v43, -v47
v_fma_f32 v91, v91, v43, -v47
v_fma_f32 v95, v95, v43, -v47
v_fma_f32 v99, v99, v43, -v47
v_fma_f32 v103, v103, v43, -v47
v_cvt_pk_bf16_f32 v32, v75, v79
v_cvt_pk_bf16_f32 v33, v83, v87
v_cvt_pk_bf16_f32 v34, v91, v95
v_cvt_pk_bf16_f32 v35, v99, v103
ds_write_b128 v4, v[32:35] offset:3072
s_waitcnt lgkmcnt(0)
s_barrier
s_waitcnt vmcnt(0)
buffer_load_dwordx4 v[144:147], v0, s[20:23], s40 offen
v_cvt_f32_i32 v108, v108
v_cvt_f32_i32 v112, v112
v_cvt_f32_i32 v116, v116
v_cvt_f32_i32 v120, v120
v_cvt_f32_i32 v124, v124
buffer_load_dwordx4 v[148:151], v0, s[20:23], s41 offen
v_cvt_f32_i32 v128, v128
v_cvt_f32_i32 v132, v132
v_cvt_f32_i32 v136, v136
v_fma_f32 v108, v108, v56, -v60
v_fma_f32 v112, v112, v56, -v60
buffer_load_dwordx4 v[152:155], v0, s[20:23], s42 offen
v_fma_f32 v116, v116, v56, -v60
v_fma_f32 v120, v120, v56, -v60
v_fma_f32 v124, v124, v56, -v60
v_fma_f32 v128, v128, v56, -v60
v_fma_f32 v132, v132, v56, -v60
v_fma_f32 v136, v136, v56, -v60
buffer_load_dwordx4 v[156:159], v0, s[20:23], s43 offen
v_cvt_pk_bf16_f32 v20, v108, v112
v_cvt_pk_bf16_f32 v21, v116, v120
v_cvt_pk_bf16_f32 v22, v124, v128
v_cvt_pk_bf16_f32 v23, v132, v136
ds_write_b128 v4, v[20:23] offset:18560
buffer_load_dwordx4 v[160:163], v0, s[20:23], s44 offen
ds_read_b128 v[40:43], v2 offset:2304
ds_read_b128 v[44:47], v2 offset:12672
ds_read_b128 v[48:51], v3 offset:2304
ds_read_b128 v[52:55], v3 offset:12672
v_cvt_f32_i32 v109, v109
buffer_load_dwordx4 v[164:167], v0, s[20:23], s45 offen
v_cvt_f32_i32 v113, v113
v_cvt_f32_i32 v117, v117
v_cvt_f32_i32 v121, v121
v_cvt_f32_i32 v125, v125
v_cvt_f32_i32 v129, v129
buffer_load_dwordx4 v[168:171], v0, s[20:23], s46 offen
v_cvt_f32_i32 v133, v133
v_cvt_f32_i32 v137, v137
v_fma_f32 v109, v109, v57, -v61
v_fma_f32 v113, v113, v57, -v61
v_fma_f32 v117, v117, v57, -v61
buffer_load_dwordx4 v[172:175], v0, s[20:23], s47 offen
v_fma_f32 v121, v121, v57, -v61
v_fma_f32 v125, v125, v57, -v61
v_fma_f32 v129, v129, v57, -v61
v_fma_f32 v133, v133, v57, -v61
v_fma_f32 v137, v137, v57, -v61
buffer_load_dwordx4 v[176:179], v1, s[20:23], 0 offen
s_add_u32 s37, s37, 1
s_cmp_eq_u32 s37, 9
s_cselect_b32 s37, 0, s37
s_mul_i32 s51, s37, 1179648
s_add_u32 s20, s6, s51
s_addc_u32 s21, s7, 0
v_cvt_pk_bf16_f32 v24, v109, v113
v_cvt_pk_bf16_f32 v25, v117, v121
v_cvt_pk_bf16_f32 v26, v125, v129
v_cvt_pk_bf16_f32 v27, v133, v137
ds_write_b128 v4, v[24:27] offset:19584
buffer_load_dwordx4 v[72:75], v0, s[20:23], s40 offen
v_cvt_f32_i32 v140, v140
v_cvt_f32_i32 v141, v141
v_cvt_f32_i32 v142, v142
v_cvt_f32_i32 v143, v143
v_fma_f32 v140, v140, v64, -v68
v_fma_f32 v141, v141, v65, -v69
buffer_load_dwordx4 v[76:79], v0, s[20:23], s41 offen
v_fma_f32 v142, v142, v66, -v70
v_fma_f32 v143, v143, v67, -v71
v_cvt_pk_bf16_f32 v36, v140, v141
v_cvt_pk_bf16_f32 v37, v142, v143
ds_write_b64 v5, v[36:37] offset:18560
buffer_load_dwordx4 v[80:83], v0, s[20:23], s42 offen
v_cvt_f32_i32 v110, v110
v_cvt_f32_i32 v114, v114
v_cvt_f32_i32 v118, v118
v_cvt_f32_i32 v122, v122
v_cvt_f32_i32 v126, v126
buffer_load_dwordx4 v[84:87], v0, s[20:23], s43 offen
v_cvt_f32_i32 v130, v130
v_cvt_f32_i32 v134, v134
v_cvt_f32_i32 v138, v138
v_fma_f32 v110, v110, v58, -v62
v_fma_f32 v114, v114, v58, -v62
buffer_load_dwordx4 v[88:91], v0, s[20:23], s44 offen
v_fma_f32 v118, v118, v58, -v62
v_fma_f32 v122, v122, v58, -v62
v_fma_f32 v126, v126, v58, -v62
v_fma_f32 v130, v130, v58, -v62
v_fma_f32 v134, v134, v58, -v62
buffer_load_dwordx4 v[92:95], v0, s[20:23], s45 offen
v_fma_f32 v138, v138, v58, -v62
v_cvt_pk_bf16_f32 v28, v110, v114
v_cvt_pk_bf16_f32 v29, v118, v122
v_cvt_pk_bf16_f32 v30, v126, v130
v_cvt_pk_bf16_f32 v31, v134, v138
ds_write_b128 v4, v[28:31] offset:20608
buffer_load_dwordx4 v[96:99], v0, s[20:23], s46 offen
v_cvt_f32_i32 v111, v111
v_cvt_f32_i32 v115, v115
v_cvt_f32_i32 v119, v119
v_cvt_f32_i32 v123, v123
v_cvt_f32_i32 v127, v127
buffer_load_dwordx4 v[100:103], v0, s[20:23], s47 offen
v_cvt_f32_i32 v131, v131
v_cvt_f32_i32 v135, v135
v_cvt_f32_i32 v139, v139
v_fma_f32 v111, v111, v59, -v63
v_fma_f32 v115, v115, v59, -v63
buffer_load_dwordx4 v[104:107], v1, s[20:23], 0 offen
s_add_u32 s37, s37, 1
s_cmp_eq_u32 s37, 9
s_cselect_b32 s37, 0, s37
s_mul_i32 s51, s37, 1179648
s_add_u32 s20, s6, s51
s_addc_u32 s21, s7, 0
v_fma_f32 v119, v119, v59, -v63
v_fma_f32 v123, v123, v59, -v63
v_fma_f32 v127, v127, v59, -v63
v_fma_f32 v131, v131, v59, -v63
v_fma_f32 v135, v135, v59, -v63
v_fma_f32 v139, v139, v59, -v63
v_cvt_pk_bf16_f32 v32, v111, v115
v_cvt_pk_bf16_f32 v33, v119, v123
v_cvt_pk_bf16_f32 v34, v127, v131
v_cvt_pk_bf16_f32 v35, v135, v139
ds_write_b128 v4, v[32:35] offset:21632
s_waitcnt lgkmcnt(0)
s_barrier
s_waitcnt vmcnt(9)
buffer_load_dwordx4 v[108:111], v0, s[20:23], s40 offen
v_cvt_f32_i32 v144, v144
v_cvt_f32_i32 v148, v148
v_cvt_f32_i32 v152, v152
v_cvt_f32_i32 v156, v156
v_cvt_f32_i32 v160, v160
v_cvt_f32_i32 v164, v164
v_cvt_f32_i32 v168, v168
v_cvt_f32_i32 v172, v172
v_fma_f32 v144, v144, v40, -v44
v_fma_f32 v148, v148, v40, -v44
buffer_load_dwordx4 v[112:115], v0, s[20:23], s41 offen
v_fma_f32 v152, v152, v40, -v44
v_fma_f32 v156, v156, v40, -v44
v_fma_f32 v160, v160, v40, -v44
v_fma_f32 v164, v164, v40, -v44
v_fma_f32 v168, v168, v40, -v44
v_fma_f32 v172, v172, v40, -v44
v_cvt_pk_bf16_f32 v20, v144, v148
v_cvt_pk_bf16_f32 v21, v152, v156
v_cvt_pk_bf16_f32 v22, v160, v164
v_cvt_pk_bf16_f32 v23, v168, v172
ds_write_b128 v4, v[20:23] offset:0
buffer_load_dwordx4 v[116:119], v0, s[20:23], s42 offen
ds_read_b128 v[56:59], v2 offset:3456
ds_read_b128 v[60:63], v2 offset:13824
ds_read_b128 v[64:67], v3 offset:3456
ds_read_b128 v[68:71], v3 offset:13824
v_cvt_f32_i32 v145, v145
v_cvt_f32_i32 v149, v149
v_cvt_f32_i32 v153, v153
v_cvt_f32_i32 v157, v157
v_cvt_f32_i32 v161, v161
v_cvt_f32_i32 v165, v165
buffer_load_dwordx4 v[120:123], v0, s[20:23], s43 offen
v_cvt_f32_i32 v169, v169
v_cvt_f32_i32 v173, v173
v_fma_f32 v145, v145, v41, -v45
v_fma_f32 v149, v149, v41, -v45
v_fma_f32 v153, v153, v41, -v45
v_fma_f32 v157, v157, v41, -v45
v_fma_f32 v161, v161, v41, -v45
v_fma_f32 v165, v165, v41, -v45
v_fma_f32 v169, v169, v41, -v45
v_fma_f32 v173, v173, v41, -v45
buffer_load_dwordx4 v[124:127], v0, s[20:23], s44 offen
v_cvt_pk_bf16_f32 v24, v145, v149
v_cvt_pk_bf16_f32 v25, v153, v157
v_cvt_pk_bf16_f32 v26, v161, v165
v_cvt_pk_bf16_f32 v27, v169, v173
ds_write_b128 v4, v[24:27] offset:1024
v_cvt_f32_i32 v176, v176
v_cvt_f32_i32 v177, v177
v_cvt_f32_i32 v178, v178
v_cvt_f32_i32 v179, v179
v_fma_f32 v176, v176, v48, -v52
v_fma_f32 v177, v177, v49, -v53
buffer_load_dwordx4 v[128:131], v0, s[20:23], s45 offen
v_fma_f32 v178, v178, v50, -v54
v_fma_f32 v179, v179, v51, -v55
v_cvt_pk_bf16_f32 v36, v176, v177
v_cvt_pk_bf16_f32 v37, v178, v179
ds_write_b64 v5, v[36:37] offset:0
v_cvt_f32_i32 v146, v146
v_cvt_f32_i32 v150, v150
v_cvt_f32_i32 v154, v154
v_cvt_f32_i32 v158, v158
v_cvt_f32_i32 v162, v162
buffer_load_dwordx4 v[132:135], v0, s[20:23], s46 offen
v_cvt_f32_i32 v166, v166
v_cvt_f32_i32 v170, v170
v_cvt_f32_i32 v174, v174
v_fma_f32 v146, v146, v42, -v46
v_fma_f32 v150, v150, v42, -v46
v_fma_f32 v154, v154, v42, -v46
v_fma_f32 v158, v158, v42, -v46
v_fma_f32 v162, v162, v42, -v46
v_fma_f32 v166, v166, v42, -v46
v_fma_f32 v170, v170, v42, -v46
buffer_load_dwordx4 v[136:139], v0, s[20:23], s47 offen
v_fma_f32 v174, v174, v42, -v46
v_cvt_pk_bf16_f32 v28, v146, v150
v_cvt_pk_bf16_f32 v29, v154, v158
v_cvt_pk_bf16_f32 v30, v162, v166
v_cvt_pk_bf16_f32 v31, v170, v174
ds_write_b128 v4, v[28:31] offset:2048
v_cvt_f32_i32 v147, v147
v_cvt_f32_i32 v151, v151
v_cvt_f32_i32 v155, v155
v_cvt_f32_i32 v159, v159
v_cvt_f32_i32 v163, v163
buffer_load_dwordx4 v[140:143], v1, s[20:23], 0 offen
s_add_u32 s37, s37, 1
s_cmp_eq_u32 s37, 9
s_cselect_b32 s37, 0, s37
s_mul_i32 s51, s37, 1179648
s_add_u32 s20, s6, s51
s_addc_u32 s21, s7, 0
v_cvt_f32_i32 v167, v167
v_cvt_f32_i32 v171, v171
v_cvt_f32_i32 v175, v175
v_fma_f32 v147, v147, v43, -v47
v_fma_f32 v151, v151, v43, -v47
v_fma_f32 v155, v155, v43, -v47
v_fma_f32 v159, v159, v43, -v47
v_fma_f32 v163, v163, v43, -v47
v_fma_f32 v167, v167, v43, -v47
v_fma_f32 v171, v171, v43, -v47
v_fma_f32 v175, v175, v43, -v47
v_cvt_pk_bf16_f32 v32, v147, v151
v_cvt_pk_bf16_f32 v33, v155, v159
v_cvt_pk_bf16_f32 v34, v163, v167
v_cvt_pk_bf16_f32 v35, v171, v175
ds_write_b128 v4, v[32:35] offset:3072
s_waitcnt lgkmcnt(0)
s_barrier
s_waitcnt vmcnt(9)
buffer_load_dwordx4 v[144:147], v0, s[20:23], s40 offen
v_cvt_f32_i32 v72, v72
v_cvt_f32_i32 v76, v76
v_cvt_f32_i32 v80, v80
v_cvt_f32_i32 v84, v84
v_cvt_f32_i32 v88, v88
v_cvt_f32_i32 v92, v92
v_cvt_f32_i32 v96, v96
v_cvt_f32_i32 v100, v100
v_fma_f32 v72, v72, v56, -v60
v_fma_f32 v76, v76, v56, -v60
buffer_load_dwordx4 v[148:151], v0, s[20:23], s41 offen
v_fma_f32 v80, v80, v56, -v60
v_fma_f32 v84, v84, v56, -v60
v_fma_f32 v88, v88, v56, -v60
v_fma_f32 v92, v92, v56, -v60
v_fma_f32 v96, v96, v56, -v60
v_fma_f32 v100, v100, v56, -v60
v_cvt_pk_bf16_f32 v20, v72, v76
v_cvt_pk_bf16_f32 v21, v80, v84
v_cvt_pk_bf16_f32 v22, v88, v92
v_cvt_pk_bf16_f32 v23, v96, v100
ds_write_b128 v4, v[20:23] offset:18560
buffer_load_dwordx4 v[152:155], v0, s[20:23], s42 offen
ds_read_b128 v[40:43], v2 offset:4608
ds_read_b128 v[44:47], v2 offset:14976
ds_read_b128 v[48:51], v3 offset:4608
ds_read_b128 v[52:55], v3 offset:14976
v_cvt_f32_i32 v73, v73
v_cvt_f32_i32 v77, v77
v_cvt_f32_i32 v81, v81
v_cvt_f32_i32 v85, v85
v_cvt_f32_i32 v89, v89
v_cvt_f32_i32 v93, v93
buffer_load_dwordx4 v[156:159], v0, s[20:23], s43 offen
v_cvt_f32_i32 v97, v97
v_cvt_f32_i32 v101, v101
v_fma_f32 v73, v73, v57, -v61
v_fma_f32 v77, v77, v57, -v61
v_fma_f32 v81, v81, v57, -v61
v_fma_f32 v85, v85, v57, -v61
v_fma_f32 v89, v89, v57, -v61
v_fma_f32 v93, v93, v57, -v61
v_fma_f32 v97, v97, v57, -v61
v_fma_f32 v101, v101, v57, -v61
buffer_load_dwordx4 v[160:163], v0, s[20:23], s44 offen
v_cvt_pk_bf16_f32 v24, v73, v77
v_cvt_pk_bf16_f32 v25, v81, v85
v_cvt_pk_bf16_f32 v26, v89, v93
v_cvt_pk_bf16_f32 v27, v97, v101
ds_write_b128 v4, v[24:27] offset:19584
v_cvt_f32_i32 v104, v104
v_cvt_f32_i32 v105, v105
v_cvt_f32_i32 v106, v106
v_cvt_f32_i32 v107, v107
v_fma_f32 v104, v104, v64, -v68
v_fma_f32 v105, v105, v65, -v69
buffer_load_dwordx4 v[164:167], v0, s[20:23], s45 offen
v_fma_f32 v106, v106, v66, -v70
v_fma_f32 v107, v107, v67, -v71
v_cvt_pk_bf16_f32 v36, v104, v105
v_cvt_pk_bf16_f32 v37, v106, v107
ds_write_b64 v5, v[36:37] offset:18560
v_cvt_f32_i32 v74, v74
v_cvt_f32_i32 v78, v78
v_cvt_f32_i32 v82, v82
v_cvt_f32_i32 v86, v86
v_cvt_f32_i32 v90, v90
buffer_load_dwordx4 v[168:171], v0, s[20:23], s46 offen
v_cvt_f32_i32 v94, v94
v_cvt_f32_i32 v98, v98
v_cvt_f32_i32 v102, v102
v_fma_f32 v74, v74, v58, -v62
v_fma_f32 v78, v78, v58, -v62
v_fma_f32 v82, v82, v58, -v62
v_fma_f32 v86, v86, v58, -v62
v_fma_f32 v90, v90, v58, -v62
v_fma_f32 v94, v94, v58, -v62
v_fma_f32 v98, v98, v58, -v62
buffer_load_dwordx4 v[172:175], v0, s[20:23], s47 offen
v_fma_f32 v102, v102, v58, -v62
v_cvt_pk_bf16_f32 v28, v74, v78
v_cvt_pk_bf16_f32 v29, v82, v86
v_cvt_pk_bf16_f32 v30, v90, v94
v_cvt_pk_bf16_f32 v31, v98, v102
ds_write_b128 v4, v[28:31] offset:20608
v_cvt_f32_i32 v75, v75
v_cvt_f32_i32 v79, v79
v_cvt_f32_i32 v83, v83
v_cvt_f32_i32 v87, v87
v_cvt_f32_i32 v91, v91
buffer_load_dwordx4 v[176:179], v1, s[20:23], 0 offen
s_add_u32 s37, s37, 1
s_cmp_eq_u32 s37, 9
s_cselect_b32 s37, 0, s37
s_mul_i32 s51, s37, 1179648
s_add_u32 s20, s6, s51
s_addc_u32 s21, s7, 0
v_cvt_f32_i32 v95, v95
v_cvt_f32_i32 v99, v99
v_cvt_f32_i32 v103, v103
v_fma_f32 v75, v75, v59, -v63
v_fma_f32 v79, v79, v59, -v63
v_fma_f32 v83, v83, v59, -v63
v_fma_f32 v87, v87, v59, -v63
v_fma_f32 v91, v91, v59, -v63
v_fma_f32 v95, v95, v59, -v63
v_fma_f32 v99, v99, v59, -v63
v_fma_f32 v103, v103, v59, -v63
v_cvt_pk_bf16_f32 v32, v75, v79
v_cvt_pk_bf16_f32 v33, v83, v87
v_cvt_pk_bf16_f32 v34, v91, v95
v_cvt_pk_bf16_f32 v35, v99, v103
ds_write_b128 v4, v[32:35] offset:21632
s_waitcnt lgkmcnt(0)
s_barrier
s_waitcnt vmcnt(9)
buffer_load_dwordx4 v[72:75], v0, s[20:23], s40 offen
v_cvt_f32_i32 v108, v108
v_cvt_f32_i32 v112, v112
v_cvt_f32_i32 v116, v116
v_cvt_f32_i32 v120, v120
v_cvt_f32_i32 v124, v124
v_cvt_f32_i32 v128, v128
v_cvt_f32_i32 v132, v132
v_cvt_f32_i32 v136, v136
v_fma_f32 v108, v108, v40, -v44
v_fma_f32 v112, v112, v40, -v44
buffer_load_dwordx4 v[76:79], v0, s[20:23], s41 offen
v_fma_f32 v116, v116, v40, -v44
v_fma_f32 v120, v120, v40, -v44
v_fma_f32 v124, v124, v40, -v44
v_fma_f32 v128, v128, v40, -v44
v_fma_f32 v132, v132, v40, -v44
v_fma_f32 v136, v136, v40, -v44
v_cvt_pk_bf16_f32 v20, v108, v112
v_cvt_pk_bf16_f32 v21, v116, v120
v_cvt_pk_bf16_f32 v22, v124, v128
v_cvt_pk_bf16_f32 v23, v132, v136
ds_write_b128 v4, v[20:23] offset:0
buffer_load_dwordx4 v[80:83], v0, s[20:23], s42 offen
ds_read_b128 v[56:59], v2 offset:5760
ds_read_b128 v[60:63], v2 offset:16128
ds_read_b128 v[64:67], v3 offset:5760
ds_read_b128 v[68:71], v3 offset:16128
v_cvt_f32_i32 v109, v109
v_cvt_f32_i32 v113, v113
v_cvt_f32_i32 v117, v117
v_cvt_f32_i32 v121, v121
v_cvt_f32_i32 v125, v125
v_cvt_f32_i32 v129, v129
buffer_load_dwordx4 v[84:87], v0, s[20:23], s43 offen
v_cvt_f32_i32 v133, v133
v_cvt_f32_i32 v137, v137
v_fma_f32 v109, v109, v41, -v45
v_fma_f32 v113, v113, v41, -v45
v_fma_f32 v117, v117, v41, -v45
v_fma_f32 v121, v121, v41, -v45
v_fma_f32 v125, v125, v41, -v45
v_fma_f32 v129, v129, v41, -v45
v_fma_f32 v133, v133, v41, -v45
v_fma_f32 v137, v137, v41, -v45
buffer_load_dwordx4 v[88:91], v0, s[20:23], s44 offen
v_cvt_pk_bf16_f32 v24, v109, v113
v_cvt_pk_bf16_f32 v25, v117, v121
v_cvt_pk_bf16_f32 v26, v125, v129
v_cvt_pk_bf16_f32 v27, v133, v137
ds_write_b128 v4, v[24:27] offset:1024
v_cvt_f32_i32 v140, v140
v_cvt_f32_i32 v141, v141
v_cvt_f32_i32 v142, v142
v_cvt_f32_i32 v143, v143
v_fma_f32 v140, v140, v48, -v52
v_fma_f32 v141, v141, v49, -v53
buffer_load_dwordx4 v[92:95], v0, s[20:23], s45 offen
v_fma_f32 v142, v142, v50, -v54
v_fma_f32 v143, v143, v51, -v55
v_cvt_pk_bf16_f32 v36, v140, v141
v_cvt_pk_bf16_f32 v37, v142, v143
ds_write_b64 v5, v[36:37] offset:0
v_cvt_f32_i32 v110, v110
v_cvt_f32_i32 v114, v114
v_cvt_f32_i32 v118, v118
v_cvt_f32_i32 v122, v122
v_cvt_f32_i32 v126, v126
buffer_load_dwordx4 v[96:99], v0, s[20:23], s46 offen
v_cvt_f32_i32 v130, v130
v_cvt_f32_i32 v134, v134
v_cvt_f32_i32 v138, v138
v_fma_f32 v110, v110, v42, -v46
v_fma_f32 v114, v114, v42, -v46
v_fma_f32 v118, v118, v42, -v46
v_fma_f32 v122, v122, v42, -v46
v_fma_f32 v126, v126, v42, -v46
v_fma_f32 v130, v130, v42, -v46
v_fma_f32 v134, v134, v42, -v46
buffer_load_dwordx4 v[100:103], v0, s[20:23], s47 offen
v_fma_f32 v138, v138, v42, -v46
v_cvt_pk_bf16_f32 v28, v110, v114
v_cvt_pk_bf16_f32 v29, v118, v122
v_cvt_pk_bf16_f32 v30, v126, v130
v_cvt_pk_bf16_f32 v31, v134, v138
ds_write_b128 v4, v[28:31] offset:2048
v_cvt_f32_i32 v111, v111
v_cvt_f32_i32 v115, v115
v_cvt_f32_i32 v119, v119
v_cvt_f32_i32 v123, v123
v_cvt_f32_i32 v127, v127
buffer_load_dwordx4 v[104:107], v1, s[20:23], 0 offen
s_add_u32 s37, s37, 1
s_cmp_eq_u32 s37, 9
s_cselect_b32 s37, 0, s37
s_mul_i32 s51, s37, 1179648
s_add_u32 s20, s6, s51
s_addc_u32 s21, s7, 0
v_cvt_f32_i32 v131, v131
v_cvt_f32_i32 v135, v135
v_cvt_f32_i32 v139, v139
v_fma_f32 v111, v111, v43, -v47
v_fma_f32 v115, v115, v43, -v47
v_fma_f32 v119, v119, v43, -v47
v_fma_f32 v123, v123, v43, -v47
v_fma_f32 v127, v127, v43, -v47
v_fma_f32 v131, v131, v43, -v47
v_fma_f32 v135, v135, v43, -v47
v_fma_f32 v139, v139, v43, -v47
v_cvt_pk_bf16_f32 v32, v111, v115
v_cvt_pk_bf16_f32 v33, v119, v123
v_cvt_pk_bf16_f32 v34, v127, v131
v_cvt_pk_bf16_f32 v35, v135, v139
ds_write_b128 v4, v[32:35] offset:3072
s_waitcnt lgkmcnt(0)
s_barrier
s_waitcnt vmcnt(9)
buffer_load_dwordx4 v[108:111], v0, s[20:23], s40 offen
v_cvt_f32_i32 v144, v144
v_cvt_f32_i32 v148, v148
v_cvt_f32_i32 v152, v152
v_cvt_f32_i32 v156, v156
v_cvt_f32_i32 v160, v160
v_cvt_f32_i32 v164, v164
v_cvt_f32_i32 v168, v168
v_cvt_f32_i32 v172, v172
v_fma_f32 v144, v144, v56, -v60
v_fma_f32 v148, v148, v56, -v60
buffer_load_dwordx4 v[112:115], v0, s[20:23], s41 offen
v_fma_f32 v152, v152, v56, -v60
v_fma_f32 v156, v156, v56, -v60
v_fma_f32 v160, v160, v56, -v60
v_fma_f32 v164, v164, v56, -v60
v_fma_f32 v168, v168, v56, -v60
v_fma_f32 v172, v172, v56, -v60
v_cvt_pk_bf16_f32 v20, v144, v148
v_cvt_pk_bf16_f32 v21, v152, v156
v_cvt_pk_bf16_f32 v22, v160, v164
v_cvt_pk_bf16_f32 v23, v168, v172
ds_write_b128 v4, v[20:23] offset:18560
buffer_load_dwordx4 v[116:119], v0, s[20:23], s42 offen
ds_read_b128 v[40:43], v2 offset:6912
ds_read_b128 v[44:47], v2 offset:17280
ds_read_b128 v[48:51], v3 offset:6912
ds_read_b128 v[52:55], v3 offset:17280
v_cvt_f32_i32 v145, v145
v_cvt_f32_i32 v149, v149
v_cvt_f32_i32 v153, v153
v_cvt_f32_i32 v157, v157
v_cvt_f32_i32 v161, v161
v_cvt_f32_i32 v165, v165
buffer_load_dwordx4 v[120:123], v0, s[20:23], s43 offen
v_cvt_f32_i32 v169, v169
v_cvt_f32_i32 v173, v173
v_fma_f32 v145, v145, v57, -v61
v_fma_f32 v149, v149, v57, -v61
v_fma_f32 v153, v153, v57, -v61
v_fma_f32 v157, v157, v57, -v61
v_fma_f32 v161, v161, v57, -v61
v_fma_f32 v165, v165, v57, -v61
v_fma_f32 v169, v169, v57, -v61
v_fma_f32 v173, v173, v57, -v61
buffer_load_dwordx4 v[124:127], v0, s[20:23], s44 offen
v_cvt_pk_bf16_f32 v24, v145, v149
v_cvt_pk_bf16_f32 v25, v153, v157
v_cvt_pk_bf16_f32 v26, v161, v165
v_cvt_pk_bf16_f32 v27, v169, v173
ds_write_b128 v4, v[24:27] offset:19584
v_cvt_f32_i32 v176, v176
v_cvt_f32_i32 v177, v177
v_cvt_f32_i32 v178, v178
v_cvt_f32_i32 v179, v179
v_fma_f32 v176, v176, v64, -v68
v_fma_f32 v177, v177, v65, -v69
buffer_load_dwordx4 v[128:131], v0, s[20:23], s45 offen
v_fma_f32 v178, v178, v66, -v70
v_fma_f32 v179, v179, v67, -v71
v_cvt_pk_bf16_f32 v36, v176, v177
v_cvt_pk_bf16_f32 v37, v178, v179
ds_write_b64 v5, v[36:37] offset:18560
v_cvt_f32_i32 v146, v146
v_cvt_f32_i32 v150, v150
v_cvt_f32_i32 v154, v154
v_cvt_f32_i32 v158, v158
v_cvt_f32_i32 v162, v162
buffer_load_dwordx4 v[132:135], v0, s[20:23], s46 offen
v_cvt_f32_i32 v166, v166
v_cvt_f32_i32 v170, v170
v_cvt_f32_i32 v174, v174
v_fma_f32 v146, v146, v58, -v62
v_fma_f32 v150, v150, v58, -v62
v_fma_f32 v154, v154, v58, -v62
v_fma_f32 v158, v158, v58, -v62
v_fma_f32 v162, v162, v58, -v62
v_fma_f32 v166, v166, v58, -v62
v_fma_f32 v170, v170, v58, -v62
buffer_load_dwordx4 v[136:139], v0, s[20:23], s47 offen
v_fma_f32 v174, v174, v58, -v62
v_cvt_pk_bf16_f32 v28, v146, v150
v_cvt_pk_bf16_f32 v29, v154, v158
v_cvt_pk_bf16_f32 v30, v162, v166
v_cvt_pk_bf16_f32 v31, v170, v174
ds_write_b128 v4, v[28:31] offset:20608
v_cvt_f32_i32 v147, v147
v_cvt_f32_i32 v151, v151
v_cvt_f32_i32 v155, v155
v_cvt_f32_i32 v159, v159
v_cvt_f32_i32 v163, v163
buffer_load_dwordx4 v[140:143], v1, s[20:23], 0 offen
s_add_u32 s37, s37, 1
s_cmp_eq_u32 s37, 9
s_cselect_b32 s37, 0, s37
s_mul_i32 s51, s37, 1179648
s_add_u32 s20, s6, s51
s_addc_u32 s21, s7, 0
v_cvt_f32_i32 v167, v167
v_cvt_f32_i32 v171, v171
v_cvt_f32_i32 v175, v175
v_fma_f32 v147, v147, v59, -v63
v_fma_f32 v151, v151, v59, -v63
v_fma_f32 v155, v155, v59, -v63
v_fma_f32 v159, v159, v59, -v63
v_fma_f32 v163, v163, v59, -v63
v_fma_f32 v167, v167, v59, -v63
v_fma_f32 v171, v171, v59, -v63
v_fma_f32 v175, v175, v59, -v63
v_cvt_pk_bf16_f32 v32, v147, v151
v_cvt_pk_bf16_f32 v33, v155, v159
v_cvt_pk_bf16_f32 v34, v163, v167
v_cvt_pk_bf16_f32 v35, v171, v175
ds_write_b128 v4, v[32:35] offset:21632
s_waitcnt lgkmcnt(0)
s_barrier
s_waitcnt vmcnt(9)
buffer_load_dwordx4 v[144:147], v0, s[20:23], s40 offen
v_cvt_f32_i32 v72, v72
v_cvt_f32_i32 v76, v76
v_cvt_f32_i32 v80, v80
v_cvt_f32_i32 v84, v84
v_cvt_f32_i32 v88, v88
v_cvt_f32_i32 v92, v92
v_cvt_f32_i32 v96, v96
v_cvt_f32_i32 v100, v100
v_fma_f32 v72, v72, v40, -v44
v_fma_f32 v76, v76, v40, -v44
v_fma_f32 v80, v80, v40, -v44
buffer_load_dwordx4 v[148:151], v0, s[20:23], s41 offen
v_fma_f32 v84, v84, v40, -v44
v_fma_f32 v88, v88, v40, -v44
v_fma_f32 v92, v92, v40, -v44
v_fma_f32 v96, v96, v40, -v44
v_fma_f32 v100, v100, v40, -v44
v_cvt_pk_bf16_f32 v20, v72, v76
v_cvt_pk_bf16_f32 v21, v80, v84
v_cvt_pk_bf16_f32 v22, v88, v92
v_cvt_pk_bf16_f32 v23, v96, v100
ds_write_b128 v4, v[20:23] offset:0
ds_read_b128 v[56:59], v2 offset:8064
buffer_load_dwordx4 v[152:155], v0, s[20:23], s42 offen
ds_read_b128 v[60:63], v2 offset:18432
ds_read_b128 v[64:67], v3 offset:8064
ds_read_b128 v[68:71], v3 offset:18432
v_cvt_f32_i32 v73, v73
v_cvt_f32_i32 v77, v77
v_cvt_f32_i32 v81, v81
v_cvt_f32_i32 v85, v85
v_cvt_f32_i32 v89, v89
v_cvt_f32_i32 v93, v93
v_cvt_f32_i32 v97, v97
buffer_load_dwordx4 v[156:159], v0, s[20:23], s43 offen
v_cvt_f32_i32 v101, v101
v_fma_f32 v73, v73, v41, -v45
v_fma_f32 v77, v77, v41, -v45
v_fma_f32 v81, v81, v41, -v45
v_fma_f32 v85, v85, v41, -v45
v_fma_f32 v89, v89, v41, -v45
v_fma_f32 v93, v93, v41, -v45
v_fma_f32 v97, v97, v41, -v45
v_fma_f32 v101, v101, v41, -v45
v_cvt_pk_bf16_f32 v24, v73, v77
v_cvt_pk_bf16_f32 v25, v81, v85
buffer_load_dwordx4 v[160:163], v0, s[20:23], s44 offen
v_cvt_pk_bf16_f32 v26, v89, v93
v_cvt_pk_bf16_f32 v27, v97, v101
ds_write_b128 v4, v[24:27] offset:1024
v_cvt_f32_i32 v104, v104
v_cvt_f32_i32 v105, v105
v_cvt_f32_i32 v106, v106
v_cvt_f32_i32 v107, v107
v_fma_f32 v104, v104, v48, -v52
v_fma_f32 v105, v105, v49, -v53
v_fma_f32 v106, v106, v50, -v54
v_fma_f32 v107, v107, v51, -v55
buffer_load_dwordx4 v[164:167], v0, s[20:23], s45 offen
v_cvt_pk_bf16_f32 v36, v104, v105
v_cvt_pk_bf16_f32 v37, v106, v107
ds_write_b64 v5, v[36:37] offset:0
v_cvt_f32_i32 v74, v74
v_cvt_f32_i32 v78, v78
v_cvt_f32_i32 v82, v82
v_cvt_f32_i32 v86, v86
v_cvt_f32_i32 v90, v90
v_cvt_f32_i32 v94, v94
v_cvt_f32_i32 v98, v98
v_cvt_f32_i32 v102, v102
buffer_load_dwordx4 v[168:171], v0, s[20:23], s46 offen
v_fma_f32 v74, v74, v42, -v46
v_fma_f32 v78, v78, v42, -v46
v_fma_f32 v82, v82, v42, -v46
v_fma_f32 v86, v86, v42, -v46
v_fma_f32 v90, v90, v42, -v46
v_fma_f32 v94, v94, v42, -v46
v_fma_f32 v98, v98, v42, -v46
v_fma_f32 v102, v102, v42, -v46
v_cvt_pk_bf16_f32 v28, v74, v78
v_cvt_pk_bf16_f32 v29, v82, v86
buffer_load_dwordx4 v[172:175], v0, s[20:23], s47 offen
v_cvt_pk_bf16_f32 v30, v90, v94
v_cvt_pk_bf16_f32 v31, v98, v102
ds_write_b128 v4, v[28:31] offset:2048
ds_read_b128 v[232:235], v2 offset:9216
ds_read_b128 v[236:239], v2 offset:19584
ds_read_b128 v[240:243], v3 offset:9216
ds_read_b128 v[244:247], v3 offset:19584
v_cvt_f32_i32 v75, v75
v_cvt_f32_i32 v79, v79
v_cvt_f32_i32 v83, v83
v_cvt_f32_i32 v87, v87
buffer_load_dwordx4 v[176:179], v1, s[20:23], 0 offen
s_add_u32 s37, s37, 1
s_cmp_eq_u32 s37, 9
s_cselect_b32 s37, 0, s37
s_mul_i32 s51, s37, 1179648
s_add_u32 s20, s6, s51
s_addc_u32 s21, s7, 0
v_cvt_f32_i32 v91, v91
v_cvt_f32_i32 v95, v95
v_cvt_f32_i32 v99, v99
v_cvt_f32_i32 v103, v103
v_fma_f32 v75, v75, v43, -v47
v_fma_f32 v79, v79, v43, -v47
v_fma_f32 v83, v83, v43, -v47
v_fma_f32 v87, v87, v43, -v47
v_fma_f32 v91, v91, v43, -v47
v_fma_f32 v95, v95, v43, -v47
v_fma_f32 v99, v99, v43, -v47
v_fma_f32 v103, v103, v43, -v47
v_cvt_pk_bf16_f32 v32, v75, v79
v_cvt_pk_bf16_f32 v33, v83, v87
v_cvt_pk_bf16_f32 v34, v91, v95
v_cvt_pk_bf16_f32 v35, v99, v103
ds_write_b128 v4, v[32:35] offset:3072
s_waitcnt lgkmcnt(0)
s_barrier
s_waitcnt vmcnt(9)
v_cvt_f32_i32 v108, v108
v_cvt_f32_i32 v112, v112
v_cvt_f32_i32 v116, v116
v_cvt_f32_i32 v120, v120
v_cvt_f32_i32 v124, v124
v_cvt_f32_i32 v128, v128
v_cvt_f32_i32 v132, v132
v_cvt_f32_i32 v136, v136
v_fma_f32 v108, v108, v56, -v60
v_fma_f32 v112, v112, v56, -v60
v_fma_f32 v116, v116, v56, -v60
v_fma_f32 v120, v120, v56, -v60
v_fma_f32 v124, v124, v56, -v60
v_fma_f32 v128, v128, v56, -v60
v_fma_f32 v132, v132, v56, -v60
v_fma_f32 v136, v136, v56, -v60
v_cvt_pk_bf16_f32 v20, v108, v112
v_cvt_pk_bf16_f32 v21, v116, v120
v_cvt_pk_bf16_f32 v22, v124, v128
v_cvt_pk_bf16_f32 v23, v132, v136
ds_write_b128 v4, v[20:23] offset:18560
v_cvt_f32_i32 v109, v109
v_cvt_f32_i32 v113, v113
v_cvt_f32_i32 v117, v117
v_cvt_f32_i32 v121, v121
v_cvt_f32_i32 v125, v125
v_cvt_f32_i32 v129, v129
v_cvt_f32_i32 v133, v133
v_cvt_f32_i32 v137, v137
v_fma_f32 v109, v109, v57, -v61
v_fma_f32 v113, v113, v57, -v61
v_fma_f32 v117, v117, v57, -v61
v_fma_f32 v121, v121, v57, -v61
v_fma_f32 v125, v125, v57, -v61
v_fma_f32 v129, v129, v57, -v61
v_fma_f32 v133, v133, v57, -v61
v_fma_f32 v137, v137, v57, -v61
v_cvt_pk_bf16_f32 v24, v109, v113
v_cvt_pk_bf16_f32 v25, v117, v121
v_cvt_pk_bf16_f32 v26, v125, v129
v_cvt_pk_bf16_f32 v27, v133, v137
ds_write_b128 v4, v[24:27] offset:19584
v_cvt_f32_i32 v140, v140
v_cvt_f32_i32 v141, v141
v_cvt_f32_i32 v142, v142
v_cvt_f32_i32 v143, v143
v_fma_f32 v140, v140, v64, -v68
v_fma_f32 v141, v141, v65, -v69
v_fma_f32 v142, v142, v66, -v70
v_fma_f32 v143, v143, v67, -v71
v_cvt_pk_bf16_f32 v36, v140, v141
v_cvt_pk_bf16_f32 v37, v142, v143
ds_write_b64 v5, v[36:37] offset:18560
v_cvt_f32_i32 v110, v110
v_cvt_f32_i32 v114, v114
v_cvt_f32_i32 v118, v118
v_cvt_f32_i32 v122, v122
v_cvt_f32_i32 v126, v126
v_cvt_f32_i32 v130, v130
v_cvt_f32_i32 v134, v134
v_cvt_f32_i32 v138, v138
v_fma_f32 v110, v110, v58, -v62
v_fma_f32 v114, v114, v58, -v62
v_fma_f32 v118, v118, v58, -v62
v_fma_f32 v122, v122, v58, -v62
v_fma_f32 v126, v126, v58, -v62
v_fma_f32 v130, v130, v58, -v62
v_fma_f32 v134, v134, v58, -v62
v_fma_f32 v138, v138, v58, -v62
v_cvt_pk_bf16_f32 v28, v110, v114
v_cvt_pk_bf16_f32 v29, v118, v122
v_cvt_pk_bf16_f32 v30, v126, v130
v_cvt_pk_bf16_f32 v31, v134, v138
ds_write_b128 v4, v[28:31] offset:20608
v_cvt_f32_i32 v111, v111
v_cvt_f32_i32 v115, v115
v_cvt_f32_i32 v119, v119
v_cvt_f32_i32 v123, v123
v_cvt_f32_i32 v127, v127
v_cvt_f32_i32 v131, v131
v_cvt_f32_i32 v135, v135
v_cvt_f32_i32 v139, v139
v_fma_f32 v111, v111, v59, -v63
v_fma_f32 v115, v115, v59, -v63
v_fma_f32 v119, v119, v59, -v63
v_fma_f32 v123, v123, v59, -v63
v_fma_f32 v127, v127, v59, -v63
v_fma_f32 v131, v131, v59, -v63
v_fma_f32 v135, v135, v59, -v63
v_fma_f32 v139, v139, v59, -v63
v_cvt_pk_bf16_f32 v32, v111, v115
v_cvt_pk_bf16_f32 v33, v119, v123
v_cvt_pk_bf16_f32 v34, v127, v131
v_cvt_pk_bf16_f32 v35, v135, v139
ds_write_b128 v4, v[32:35] offset:21632
s_waitcnt lgkmcnt(0)
s_barrier
s_waitcnt vmcnt(0)
v_cvt_f32_i32 v144, v144
v_cvt_f32_i32 v148, v148
v_cvt_f32_i32 v152, v152
v_cvt_f32_i32 v156, v156
v_cvt_f32_i32 v160, v160
v_cvt_f32_i32 v164, v164
v_cvt_f32_i32 v168, v168
v_cvt_f32_i32 v172, v172
v_fma_f32 v144, v144, v232, -v236
v_fma_f32 v148, v148, v232, -v236
v_fma_f32 v152, v152, v232, -v236
v_fma_f32 v156, v156, v232, -v236
v_fma_f32 v160, v160, v232, -v236
v_fma_f32 v164, v164, v232, -v236
v_fma_f32 v168, v168, v232, -v236
v_fma_f32 v172, v172, v232, -v236
v_cvt_pk_bf16_f32 v20, v144, v148
v_cvt_pk_bf16_f32 v21, v152, v156
v_cvt_pk_bf16_f32 v22, v160, v164
v_cvt_pk_bf16_f32 v23, v168, v172
ds_write_b128 v4, v[20:23] offset:37120
v_cvt_f32_i32 v145, v145
v_cvt_f32_i32 v149, v149
v_cvt_f32_i32 v153, v153
v_cvt_f32_i32 v157, v157
v_cvt_f32_i32 v161, v161
v_cvt_f32_i32 v165, v165
v_cvt_f32_i32 v169, v169
v_cvt_f32_i32 v173, v173
v_fma_f32 v145, v145, v233, -v237
v_fma_f32 v149, v149, v233, -v237
v_fma_f32 v153, v153, v233, -v237
v_fma_f32 v157, v157, v233, -v237
v_fma_f32 v161, v161, v233, -v237
v_fma_f32 v165, v165, v233, -v237
v_fma_f32 v169, v169, v233, -v237
v_fma_f32 v173, v173, v233, -v237
v_cvt_pk_bf16_f32 v24, v145, v149
v_cvt_pk_bf16_f32 v25, v153, v157
v_cvt_pk_bf16_f32 v26, v161, v165
v_cvt_pk_bf16_f32 v27, v169, v173
ds_write_b128 v4, v[24:27] offset:38144
v_cvt_f32_i32 v176, v176
v_cvt_f32_i32 v177, v177
v_cvt_f32_i32 v178, v178
v_cvt_f32_i32 v179, v179
v_fma_f32 v176, v176, v240, -v244
v_fma_f32 v177, v177, v241, -v245
v_fma_f32 v178, v178, v242, -v246
v_fma_f32 v179, v179, v243, -v247
v_cvt_pk_bf16_f32 v36, v176, v177
v_cvt_pk_bf16_f32 v37, v178, v179
ds_write_b64 v5, v[36:37] offset:37120
v_cvt_f32_i32 v146, v146
v_cvt_f32_i32 v150, v150
v_cvt_f32_i32 v154, v154
v_cvt_f32_i32 v158, v158
v_cvt_f32_i32 v162, v162
v_cvt_f32_i32 v166, v166
v_cvt_f32_i32 v170, v170
v_cvt_f32_i32 v174, v174
v_fma_f32 v146, v146, v234, -v238
v_fma_f32 v150, v150, v234, -v238
v_fma_f32 v154, v154, v234, -v238
v_fma_f32 v158, v158, v234, -v238
v_fma_f32 v162, v162, v234, -v238
v_fma_f32 v166, v166, v234, -v238
v_fma_f32 v170, v170, v234, -v238
v_fma_f32 v174, v174, v234, -v238
v_cvt_pk_bf16_f32 v28, v146, v150
v_cvt_pk_bf16_f32 v29, v154, v158
v_cvt_pk_bf16_f32 v30, v162, v166
v_cvt_pk_bf16_f32 v31, v170, v174
ds_write_b128 v4, v[28:31] offset:39168
v_cvt_f32_i32 v147, v147
v_cvt_f32_i32 v151, v151
v_cvt_f32_i32 v155, v155
v_cvt_f32_i32 v159, v159
v_cvt_f32_i32 v163, v163
v_cvt_f32_i32 v167, v167
v_cvt_f32_i32 v171, v171
v_cvt_f32_i32 v175, v175
v_fma_f32 v147, v147, v235, -v239
v_fma_f32 v151, v151, v235, -v239
v_fma_f32 v155, v155, v235, -v239
v_fma_f32 v159, v159, v235, -v239
v_fma_f32 v163, v163, v235, -v239
v_fma_f32 v167, v167, v235, -v239
v_fma_f32 v171, v171, v235, -v239
v_fma_f32 v175, v175, v235, -v239
v_cvt_pk_bf16_f32 v32, v147, v151
v_cvt_pk_bf16_f32 v33, v155, v159
v_cvt_pk_bf16_f32 v34, v163, v167
v_cvt_pk_bf16_f32 v35, v171, v175
ds_write_b128 v4, v[32:35] offset:40192
s_waitcnt lgkmcnt(0)
s_barrier
L_end:
s_endpgm
.section .rodata,"a"
.p2align 6
.amdhsa_kernel standalone__weight_only_int_quip_2__prompt_kernel
  .amdhsa_next_free_vgpr 256
  .amdhsa_next_free_sgpr 64
  .amdhsa_accum_offset 256
  .amdhsa_group_segment_fixed_size 0
  .amdhsa_kernarg_size 56
  .amdhsa_user_sgpr_count 2
  .amdhsa_user_sgpr_kernarg_segment_ptr 1
  .amdhsa_system_sgpr_workgroup_id_x 1
  .amdhsa_float_denorm_mode_32 3
.end_amdhsa_kernel
```
